```python
import torch

def _softmax(x, axis=-1):
    return torch.softmax(x, dim=axis)
def _gelu(x):
    return torch.nn.functional.gelu(x, approximate="tanh")
def _silu(x):
    return torch.nn.functional.silu(x)
def _sigmoid(x):
    return torch.sigmoid(x)
def _layernorm(x, axis=-1, eps=1e-5):
    m = x.mean(dim=axis, keepdim=True)
    v = x.var(dim=axis, keepdim=True, unbiased=False)
    return (x - m) / torch.sqrt(v + eps)
def _scatter_add(tgt, idx, src, axis=0):
    return tgt.clone().index_add_(axis, idx, src)
def _segment_sum(src, seg, n):
    out = torch.zeros((n,) + src.shape[1:], dtype=src.dtype)
    return out.index_add_(0, seg, src)
def _pad(x, pw):
    flat = tuple(v for pair in reversed(pw) for v in pair)
    return torch.nn.functional.pad(x, flat)

kernel_name = 'concat_heads__ssm_conv_s4__linear_kernel_hedgehog__prompt'

def setup_inputs():

    _w = (lambda a: (lambda t: t.to(torch.bfloat16) if t.is_floating_point() else t)(torch.as_tensor(a)))
    def _A_setup():
        B, L, D, N = 1, 2048, 512, 128
        A_re = -(lambda _x: torch.exp(torch.as_tensor(_x)))((lambda *s: torch.randn(*s, dtype=torch.bfloat16) * 3.2)(D, N))
        A_im = torch.pi * (lambda *s: torch.randn(*s, dtype=torch.bfloat16) * 0.2)(D, N)
        B_re = (lambda *s: torch.randn(*s, dtype=torch.bfloat16) * 0.4)(D, N)
        B_im = (lambda *s: torch.randn(*s, dtype=torch.bfloat16) * 0.4)(D, N)
        C_re = (lambda *s: torch.randn(*s, dtype=torch.bfloat16) * 0.4)(D, N)
        C_im = (lambda *s: torch.randn(*s, dtype=torch.bfloat16) * 0.4)(D, N)
        log_dt = (lambda *s: torch.randn(*s, dtype=torch.bfloat16) * 0.2)(D) * 0.5 - 4.0
        Dskip = (lambda *s: torch.randn(*s, dtype=torch.bfloat16) * 0.4)(D)
        return {
            "u": _w((lambda *s: torch.randn(*s, dtype=torch.bfloat16) * 0.05)(B, L, D)),
            "A_re": _w(A_re),
            "A_im": _w(A_im),
            "B_re": _w(B_re),
            "B_im": _w(B_im),
            "C_re": _w(C_re),
            "C_im": _w(C_im),
            "log_dt": _w(log_dt),
            "Dskip": _w(Dskip),
        }
    _A_in = _A_setup()

    def _B_setup():
        B, S, D, H = 1, 2048, 512, 32
        Dh = D // H
        return {
            "x": _w((lambda *s: torch.randn(*s, dtype=torch.bfloat16) * 0.4)(B, S, D)),
            "wqkv": _w((lambda *s: torch.randn(*s, dtype=torch.bfloat16) * 0.4)(D, 3 * D)),
            "w_phi": _w((lambda *s: torch.randn(*s, dtype=torch.bfloat16) * 0.4)(H, Dh, Dh) * (Dh ** -0.5)),
            "wo": _w((lambda *s: torch.randn(*s, dtype=torch.bfloat16) * 0.05)(D, D)),
        }
    _B_in = _B_setup()

    return {
        "A_u": _A_in["u"],
        "A_A_re": _A_in["A_re"],
        "A_A_im": _A_in["A_im"],
        "A_B_re": _A_in["B_re"],
        "A_B_im": _A_in["B_im"],
        "A_C_re": _A_in["C_re"],
        "A_C_im": _A_in["C_im"],
        "A_log_dt": _A_in["log_dt"],
        "A_Dskip": _A_in["Dskip"],
        "B_x": _B_in["x"],
        "B_wqkv": _B_in["wqkv"],
        "B_w_phi": _B_in["w_phi"],
        "B_wo": _B_in["wo"],
    }

def reference(A_u, A_A_re, A_A_im, A_B_re, A_B_im, A_C_re, A_C_im, A_log_dt, A_Dskip, B_x, B_wqkv, B_w_phi, B_wo):
    def _A_ref(u, A_re, A_im, B_re, B_im, C_re, C_im, log_dt, Dskip):
        Bsz, L, D = u.shape
        dt = torch.exp(log_dt)[:, None]
        A = A_re + 1j * A_im
        Bc = B_re + 1j * B_im
        Cc = C_re + 1j * C_im
        logdA = dt * A
        dB = dt * Bc
        l = (lambda x, dt: x.to(dt))(torch.arange(L), A_re.dtype)
        P = torch.exp(logdA[:, :, None] * l[None, None, :])
        K = torch.einsum("dn,dnl,dn->dl", Cc, P, dB).real
        L2 = 2 * L
        Kp = _pad(K, ((0, 0), (0, L)))
        up = (lambda x, *d: x.permute(*d))(u, 0, 2, 1)
        up = _pad(up, ((0, 0), (0, 0), (0, L)))
        Kf = (lambda x, axes=(-2,-1): torch.fft.rfft2(x.float(), dim=axes))(Kp[:, None, :], axes=(-2, -1))
        Uf = (lambda x, axes=(-2,-1): torch.fft.rfft2(x.float(), dim=axes))(up[:, :, None, :], axes=(-2, -1))
        Yf = Uf * Kf[None, :, :, :]
        y = (lambda x, s, axes=(-2,-1): torch.fft.irfft2(x, s=s, dim=axes).to(torch.bfloat16))(Yf, (1, L2), axes=(-2, -1))[:, :, 0, :L]
        y = (lambda x, *d: x.permute(*d))(y, 0, 2, 1) + u * Dskip[None, None, :]
        return y

    def _B_ref(x, wqkv, w_phi, wo):
        B, S, D = x.shape
        H = 32; Dh = D // H
        qkv = (lambda x, *d: x.permute(*d))((x @ wqkv).reshape(B, S, 3, H, Dh), 2, 0, 3, 1, 4)
        q, k, v = qkv[0], qkv[1], qkv[2]
        pq = torch.einsum("bhsd,hdf->bhsf", q, w_phi)
        pk = torch.einsum("bhsd,hdf->bhsf", k, w_phi)
        phi_q = torch.concatenate([_softmax(pq, axis=-1), _softmax(-pq, axis=-1)], axis=-1)
        phi_k = torch.concatenate([_softmax(pk, axis=-1), _softmax(-pk, axis=-1)], axis=-1)
        kv = torch.einsum("bhsf,bhsd->bhfd", phi_k, v)
        z  = torch.einsum("bhsf->bhf", phi_k)
        num = torch.einsum("bhqf,bhfd->bhqd", phi_q, kv)
        den = torch.einsum("bhqf,bhf->bhq", phi_q, z)[..., None] + 1e-6
        o = num / den
        return (lambda x, *d: x.permute(*d))(o, 0, 2, 1, 3).reshape(B, S, D) @ wo

    a = _A_ref(A_u, A_A_re, A_A_im, A_B_re, A_B_im, A_C_re, A_C_im, A_log_dt, A_Dskip)
    b = _B_ref(B_x, B_wqkv, B_w_phi, B_wo)
    return torch.concatenate([a, b], axis=-1)
```

```asm
; @launch grid=(512,1,1) block=(256,1,1) lds=81920
.amdgcn_target "amdgcn-amd-amdhsa--gfx950"
.text
.globl concat_heads__ssm_conv_s4__linear_kernel_hedgehog__prompt_kernel
.p2align 8
.type concat_heads__ssm_conv_s4__linear_kernel_hedgehog__prompt_kernel,@function
concat_heads__ssm_conv_s4__linear_kernel_hedgehog__prompt_kernel:
    s_cmp_ge_u32 s2, 512
    s_cbranch_scc1 K_EXIT
    s_getpc_b64 s[4:5]
    s_bfe_u32 s3, s2, 0x50003
    s_lshl_b32 s3, s3, 10
    v_lshl_add_u32 v255, v0, 7, s3
    v_cmp_gt_u32 vcc, 8, v0
    s_nop 0
    s_and_saveexec_b64 s[6:7], vcc
    s_cbranch_execz K_NOPF
    global_load_dword v254, v255, s[4:5]
K_NOPF:
    s_mov_b64 exec, s[6:7]
    s_cmp_lt_u32 s2, 256
    s_cbranch_scc1 B_ROLE
A_ROLE:
    s_load_dwordx2 s[8:9], s[0:1], 0
    s_load_dwordx2 s[12:13], s[0:1], 8
    s_load_dwordx2 s[16:17], s[0:1], 16
    s_load_dwordx2 s[20:21], s[0:1], 24
    s_load_dwordx2 s[24:25], s[0:1], 32
    s_load_dwordx2 s[28:29], s[0:1], 40
    s_load_dwordx2 s[32:33], s[0:1], 48
    s_load_dwordx4 s[52:55], s[0:1], 56
    s_load_dwordx2 s[36:37], s[0:1], 104
    s_load_dwordx2 s[40:41], s[0:1], 120
    s_setprio 3
    v_lshrrev_b32 v3, 6, v0
    v_and_b32 v2, 63, v0
    v_readfirstlane_b32 s46, v3
    s_and_b32 s44, s2, 7
    s_bfe_u32 s45, s2, 0x50003
    s_lshr_b32 s47, s46, 1
    s_and_b32 s48, s46, 1
    v_bfe_u32 v4, v0, 4, 1
    v_lshlrev_b32 v4, 2, v4
    v_and_b32 v5, 7, v0
    v_xor_b32 v4, v4, v5
    v_lshlrev_b32 v4, 4, v4
    v_lshrrev_b32 v5, 3, v0
    v_lshl_add_u32 v19, v5, 10, v4
    s_lshl_b32 s49, s45, 16
    s_lshl_b32 s50, s44, 7
    s_add_u32 s62, s49, s50
    s_add_u32 s63, s62, 32768
    s_lshl_b32 s49, s44, 5
    s_add_u32 s49, s49, s45
    s_lshl_b32 s51, s49, 2
    s_add_u32 s50, s51, s46
    s_lshl_b32 s64, s50, 7
    v_lshlrev_b32 v10, 1, v2
    v_mov_b32 v1, 0
    s_lshl_b32 s65, s44, 8
    s_mov_b32 s10, 0x200000
    s_mov_b32 s11, 0x20000
    s_mov_b32 s14, 0x20000
    s_mov_b32 s15, 0x20000
    s_mov_b32 s18, 0x20000
    s_mov_b32 s19, 0x20000
    s_mov_b32 s22, 0x20000
    s_mov_b32 s23, 0x20000
    s_mov_b32 s26, 0x20000
    s_mov_b32 s27, 0x20000
    s_mov_b32 s30, 0x20000
    s_mov_b32 s31, 0x20000
    s_mov_b32 s34, 0x20000
    s_mov_b32 s35, 0x20000
    s_mov_b32 s38, 0x400000
    s_mov_b32 s39, 0x20000
    s_mov_b32 s42, 0x10000000
    s_mov_b32 s43, 0x20000
    s_waitcnt lgkmcnt(0)
    buffer_load_dword v1, v1, s[40:43], s65 offen offset:256 sc1
    buffer_load_ushort v12, v10, s[12:15], s64 offen
    buffer_load_ushort v13, v10, s[16:19], s64 offen
    buffer_load_ushort v14, v10, s[20:23], s64 offen
    buffer_load_ushort v15, v10, s[24:27], s64 offen
    buffer_load_ushort v16, v10, s[28:31], s64 offen
    buffer_load_ushort v17, v10, s[32:35], s64 offen
    s_load_dword s56, s[52:53], s51
    s_load_dword s57, s[54:55], s51
    s_setprio 3
    s_lshl_b32 s3, s46, 10
    s_add_u32 m0, s3, 62016
    s_nop 0
    buffer_load_dwordx4 v19, s[8:11], s62 offen  lds
    s_add_u32 m0, s3, 66112
    s_nop 0
    buffer_load_dwordx4 v19, s[8:11], s63 offen  lds
    s_setprio 2
    s_branch A_REST
B_ROLE:
    s_load_dwordx4 s[8:11], s[0:1], 72
    s_load_dwordx2 s[16:17], s[0:1], 88
    s_load_dwordx2 s[20:21], s[0:1], 96
    s_load_dwordx2 s[24:25], s[0:1], 104
    s_load_dwordx2 s[28:29], s[0:1], 120
    s_setprio 1
    v_lshrrev_b32 v104, 6, v0
    s_and_b32 s36, s2, 7
    s_lshr_b32 s35, s2, 3
    v_readfirstlane_b32 s34, v104
    s_and_b32 s62, s35, 1
    s_lshl1_add_u32 s32, s36, s62
    s_lshr_b32 s33, s35, 1
    s_and_b32 s61, s33, 1
    s_lshl1_add_u32 s61, s61, s62
    s_lshr_b32 s63, s33, 1
    s_lshl1_add_u32 s61, s61, s63
    s_add_u32 s61, s61, s36
    s_and_b32 s61, s61, 7
    s_and_b32 s61, s61, 6
    s_lshl_b32 s40, s61, 7
    s_mul_i32 s48, s40, 1536
    v_bfe_u32 v105, v0, 3, 3
    v_lshl_add_u32 v105, v104, 5, v105
    v_and_b32 v106, 7, v0
    v_bfe_u32 v107, v0, 4, 2
    v_xor_b32 v106, v106, v107
    v_lshlrev_b32 v106, 4, v106
    s_lshl_b32 s61, s32, 17
    v_lshl_add_u32 v105, v105, 10, v106
    v_add_u32 v96, s61, v105
    v_xor_b32 v97, 64, v96
    v_add_u32 v98, 16384, v96
    v_add_u32 v97, 8192, v97
    v_add_u32 v99, 16384, v97
    v_lshrrev_b32 v105, 2, v0
    v_mul_u32_u24 v105, 3072, v105
    v_and_b32 v106, 3, v0
    v_lshl_add_u32 v105, v106, 4, v105
    s_lshl_b32 s61, s33, 6
    s_add_u32 s61, s61, 1024
    v_add_u32 v3, s61, v105
    s_lshl_b32 s37, s34, 10
    s_lshl_b32 s38, s34, 12
    s_mov_b32 s14, 0x180000
    s_mov_b32 s15, 0x20000
    s_waitcnt lgkmcnt(0)
    s_mov_b32 s12, s10
    s_mov_b32 s13, s11
    s_mov_b32 s10, 0x200000
    s_mov_b32 s11, 0x20000
    s_add_u32 m0, s38, 49152
    s_nop 0
    buffer_load_dwordx4 v96, s[8:11], s40 offen  lds
    s_add_u32 m0, s38, 50176
    s_nop 0
    buffer_load_dwordx4 v97, s[8:11], s40 offen  lds
    s_add_u32 m0, s38, 51200
    s_nop 0
    buffer_load_dwordx4 v98, s[8:11], s40 offen  lds
    s_add_u32 m0, s38, 52224
    s_nop 0
    buffer_load_dwordx4 v99, s[8:11], s40 offen  lds
    s_add_u32 m0, s37, 0
    s_nop 0
    buffer_load_dwordx4 v3, s[12:15], s48 offen  lds
    v_and_b32 v4, 63, v0
    v_lshlrev_b32 v4, 4, v4
    v_mov_b32 v5, 0
    s_mov_b32 s18, 0x4000
    s_mov_b32 s19, 0x20000
    s_mov_b32 s30, 0x10000000
    s_mov_b32 s31, 0x20000
    s_lshl_b32 s62, s33, 10
    s_add_u32 m0, s37, 28672
    s_add_u32 s41, s40, 128
    s_and_b32 s41, s41, 1023
    s_mul_i32 s49, s41, 1536
    buffer_load_dwordx4 v4, s[16:19], s62 offen lds
    buffer_load_dword v5, v5, s[28:31], 0 offen offset:0 sc1
    s_add_u32 s42, s41, 128
    s_and_b32 s42, s42, 1023
    s_mul_i32 s50, s42, 1536
    s_add_u32 s43, s42, 128
    s_and_b32 s43, s43, 1023
    s_mul_i32 s51, s43, 1536
    s_add_u32 s44, s43, 128
    s_and_b32 s44, s44, 1023
    s_mul_i32 s52, s44, 1536
    s_add_u32 s45, s44, 128
    s_and_b32 s45, s45, 1023
    s_mul_i32 s53, s45, 1536
    s_add_u32 s46, s45, 128
    s_and_b32 s46, s46, 1023
    s_mul_i32 s54, s46, 1536
    s_add_u32 s47, s46, 128
    s_and_b32 s47, s47, 1023
    s_mul_i32 s55, s47, 1536
    s_add_u32 m0, s38, 65536
    s_nop 0
    buffer_load_dwordx4 v96, s[8:11], s41 offen  lds
    s_add_u32 m0, s38, 66560
    s_nop 0
    buffer_load_dwordx4 v97, s[8:11], s41 offen  lds
    s_add_u32 m0, s38, 67584
    s_nop 0
    buffer_load_dwordx4 v98, s[8:11], s41 offen  lds
    s_add_u32 m0, s38, 68608
    s_nop 0
    buffer_load_dwordx4 v99, s[8:11], s41 offen  lds
    s_add_u32 m0, s37, 4096
    s_nop 0
    buffer_load_dwordx4 v3, s[12:15], s49 offen  lds
    s_add_u32 m0, s38, 32768
    s_nop 0
    buffer_load_dwordx4 v96, s[8:11], s42 offen  lds
    s_add_u32 m0, s38, 33792
    s_nop 0
    buffer_load_dwordx4 v97, s[8:11], s42 offen  lds
    s_add_u32 m0, s38, 34816
    s_nop 0
    buffer_load_dwordx4 v98, s[8:11], s42 offen  lds
    s_add_u32 m0, s38, 35840
    s_nop 0
    buffer_load_dwordx4 v99, s[8:11], s42 offen  lds
    s_add_u32 m0, s37, 8192
    s_nop 0
    buffer_load_dwordx4 v3, s[12:15], s50 offen  lds
    s_mov_b32 s22, 0x80000
    s_mov_b32 s23, 0x20000
    s_mov_b32 s26, 0x400000
    s_mov_b32 s27, 0x20000
    v_bfe_u32 v48, v0, 2, 2
    v_and_b32 v49, 3, v0
    v_bfe_u32 v50, v0, 4, 1
    v_bfe_u32 v51, v0, 5, 1
    v_lshl_add_u32 v104, v51, 3, v48
    v_lshlrev_b32 v104, 6, v104
    v_lshl_add_u32 v105, v50, 2, v49
    v_lshl_add_u32 v1, v105, 3, v104
    v_and_b32 v105, 1, v49
    v_lshl_add_u32 v106, v105, 1, v50
    v_lshrrev_b32 v107, 1, v49
    v_lshl_add_u32 v106, v106, 1, v107
    v_lshl_add_u32 v2, v106, 3, v104
    s_add_u32 s61, s38, 32768
    v_bfe_u32 v104, v0, 1, 3
    v_xor_b32 v104, v104, v51
    v_lshlrev_b32 v104, 4, v104
    v_and_b32 v108, 31, v0
    v_lshl_add_u32 v104, v108, 7, v104
    v_add_u32 v100, s61, v104
    v_xor_b32 v101, 32, v100
    v_xor_b32 v102, 64, v100
    v_xor_b32 v103, 96, v100
    v_lshl_add_u32 v106, v50, 1, v107
    v_lshlrev_b32 v106, 3, v106
    v_lshl_add_u32 v106, v105, 9, v106
    v_lshl_add_u32 v104, v51, 2, v48
    v_lshl_add_u32 v106, v104, 5, v106
    s_add_u32 s61, s37, 28672
    v_add_u32 v109, s61, v106
    s_getreg_b32 s77, hwreg(HW_REG_XCC_ID, 0, 4)
    s_mov_b32 s64, 0x3fb8aa3b
    s_and_b32 s4, s34, 1
    s_lshr_b32 s5, s34, 1
    v_bfe_u32 v52, v0, 1, 2
    v_lshlrev_b32 v88, 4, v52
    v_lshl_add_u32 v88, v108, 6, v88
    v_lshl_add_u32 v88, v51, 11, v88
    s_add_u32 s61, s38, 65536
    v_add_u32 v88, s61, v88
    v_bfe_u32 v52, v0, 2, 1
    v_lshlrev_b32 v89, 4, v52
    v_lshl_add_u32 v89, v108, 5, v89
    v_lshl_add_u32 v89, v51, 10, v89
    s_add_u32 s61, s38, 32768
    v_add_u32 v89, s61, v89
    v_lshrrev_b32 v52, 1, v48
    v_lshl_add_u32 v52, v50, 1, v52
    s_lshl_b32 s62, s4, 1
    v_or_b32 v53, s62, v107
    v_xor_b32 v53, v53, v52
    v_bfe_u32 v54, v0, 2, 4
    v_lshlrev_b32 v55, 3, v105
    v_lshl_add_u32 v90, v53, 4, v55
    v_lshl_add_u32 v90, v54, 6, v90
    s_lshl_b32 s61, s5, 11
    s_add_u32 s61, s61, 65536
    v_add_u32 v90, s61, v90
    v_xor_b32 v53, v107, v50
    v_lshl_add_u32 v91, v53, 4, v55
    v_lshl_add_u32 v91, v54, 5, v91
    s_lshl_b32 s61, s5, 10
    s_add_u32 s61, s61, 32768
    v_add_u32 v91, s61, v91
    v_lshlrev_b32 v52, 5, v49
    v_lshl_add_u32 v52, v50, 4, v52
    v_add_u32 v52, 512, v52
    s_mov_b32 s66, 0
    s_mov_b32 s67, -1
    v_cndmask_b32 v92, v4, v52, s[66:67]
    s_mul_i32 s61, s33, 40960
    s_mul_i32 s62, s34, 640
    s_add_u32 s61, s61, s62
    s_add_u32 s70, s61, 9437184
    s_mul_i32 s61, s32, 2560
    s_add_u32 s39, s70, s61
    s_add_u32 s71, s70, 10240
    s_add_u32 s72, s70, 20480
    s_add_u32 s73, s70, 30720
    v_mov_b32 v93, 0xfffefffe
    v_bfe_u32 v52, v0, 4, 2
    v_mul_u32_u24 v94, 2560, v52
    v_and_b32 v53, 15, v0
    v_lshl_add_u32 v94, v53, 4, v94
    v_bfe_u32 v53, v0, 1, 2
    v_lshl_add_u32 v53, v53, 2, v52
    v_mul_u32_u24 v95, 2560, v53
    v_and_b32 v53, 1, v0
    v_lshl_add_u32 v95, v53, 4, v95
    v_add_u32 v95, 512, v95
    s_lshl2_add_u32 s61, s32, s34
    s_lshl4_add_u32 s61, s61, s33
    s_lshl_b32 s16, s61, 4
    s_add_u32 s16, s16, 786432
    s_lshl_b32 s61, s61, 12
    s_add_u32 s65, s61, 1024
    s_and_b32 s61, s35, 3
    s_lshl2_add_u32 s74, s36, s61
    s_lshr_b32 s75, s35, 2
    s_waitcnt vmcnt(12)
    ds_read_b128 v[128:131], v100 offset:16384
    ds_read_b128 v[132:135], v101 offset:16384
    ds_read_b128 v[136:139], v102 offset:16384
    ds_read_b128 v[140:143], v103 offset:16384
    s_barrier
    ds_read_b64_tr_b16 v[64:65], v1 offset:0
    ds_read_b64_tr_b16 v[66:67], v1 offset:256
    ds_read_b64_tr_b16 v[68:69], v1 offset:1024
    ds_read_b64_tr_b16 v[70:71], v1 offset:1280
    ds_read_b64_tr_b16 v[72:73], v1 offset:2048
    ds_read_b64_tr_b16 v[74:75], v1 offset:2304
    ds_read_b64_tr_b16 v[76:77], v1 offset:3072
    ds_read_b64_tr_b16 v[78:79], v1 offset:3328
    s_waitcnt lgkmcnt(8)
    s_add_u32 m0, s38, 49152
    s_nop 0
    buffer_load_dwordx4 v96, s[8:11], s43 offen  lds
    s_add_u32 m0, s38, 50176
    s_nop 0
    buffer_load_dwordx4 v97, s[8:11], s43 offen  lds
    s_add_u32 m0, s38, 51200
    s_nop 0
    buffer_load_dwordx4 v98, s[8:11], s43 offen  lds
    s_add_u32 m0, s38, 52224
    s_nop 0
    buffer_load_dwordx4 v99, s[8:11], s43 offen  lds
    s_add_u32 m0, s37, 12288
    s_nop 0
    buffer_load_dwordx4 v3, s[12:15], s51 offen  lds
    s_waitcnt vmcnt(10)
    ds_read_b128 v[144:147], v100 offset:32768
    ds_read_b128 v[148:151], v101 offset:32768
    ds_read_b128 v[152:155], v102 offset:32768
    ds_read_b128 v[156:159], v103 offset:32768
    s_barrier
    ds_read_b64_tr_b16 v[32:33], v1 offset:4096
    ds_read_b64_tr_b16 v[34:35], v1 offset:4352
    ds_read_b64_tr_b16 v[36:37], v1 offset:5120
    ds_read_b64_tr_b16 v[38:39], v1 offset:5376
    ds_read_b64_tr_b16 v[40:41], v1 offset:6144
    ds_read_b64_tr_b16 v[42:43], v1 offset:6400
    ds_read_b64_tr_b16 v[44:45], v1 offset:7168
    ds_read_b64_tr_b16 v[46:47], v1 offset:7424
    ds_read_b64_tr_b16 v[8:9], v109 offset:0
    ds_read_b64_tr_b16 v[10:11], v109 offset:256
    s_waitcnt lgkmcnt(14)
    v_mfma_f32_32x32x16_bf16 v[16:31], v[64:67], v[128:131], 0
    s_waitcnt lgkmcnt(10)
    v_mfma_f32_32x32x16_bf16 v[16:31], v[68:71], v[132:135], v[16:31]
    s_add_u32 m0, s38, 65536
    s_nop 0
    buffer_load_dwordx4 v96, s[8:11], s44 offen  lds
    v_mfma_f32_32x32x16_bf16 v[16:31], v[72:75], v[136:139], v[16:31]
    s_add_u32 m0, s38, 66560
    s_nop 0
    buffer_load_dwordx4 v97, s[8:11], s44 offen  lds
    s_add_u32 m0, s38, 67584
    s_nop 0
    buffer_load_dwordx4 v98, s[8:11], s44 offen  lds
    v_mfma_f32_32x32x16_bf16 v[16:31], v[76:79], v[140:143], v[16:31]
    s_add_u32 m0, s38, 68608
    s_nop 0
    buffer_load_dwordx4 v99, s[8:11], s44 offen  lds
    s_add_u32 m0, s37, 16384
    s_nop 0
    buffer_load_dwordx4 v3, s[12:15], s52 offen  lds
    s_mov_b32 s66, 0x0f0f0f0f
    s_mov_b32 s67, 0x0f0f0f0f
    s_waitcnt lgkmcnt(1)
    v_cndmask_b32 v12, v8, 0, s[66:67]
    v_cndmask_b32 v13, v9, 0, s[66:67]
    s_waitcnt lgkmcnt(0)
    v_cndmask_b32 v14, v10, 0, s[66:67]
    v_cndmask_b32 v15, v11, 0, s[66:67]
    v_cndmask_b32 v8, 0, v8, s[66:67]
    v_cndmask_b32 v9, 0, v9, s[66:67]
    v_cndmask_b32 v10, 0, v10, s[66:67]
    v_cndmask_b32 v11, 0, v11, s[66:67]
    v_readfirstlane_b32 s60, v5
    s_nop 0
    s_add_u32 s60, s60, 1
    s_lshr_b32 s61, s60, 0
    s_and_b32 s62, s61, 1
    s_and_b32 s61, s61, 2
    s_lshl_b32 s61, s61, 15
    s_or_b32 s56, s61, s62
    s_lshr_b32 s61, s60, 2
    s_and_b32 s62, s61, 1
    s_and_b32 s61, s61, 2
    s_lshl_b32 s61, s61, 15
    s_or_b32 s57, s61, s62
    s_lshr_b32 s61, s60, 4
    s_and_b32 s62, s61, 1
    s_and_b32 s61, s61, 2
    s_lshl_b32 s61, s61, 15
    s_or_b32 s58, s61, s62
    s_lshr_b32 s61, s60, 6
    s_and_b32 s62, s61, 1
    s_and_b32 s61, s61, 2
    s_lshl_b32 s61, s61, 15
    s_or_b32 s59, s61, s62
    s_waitcnt vmcnt(10)
    ds_read_b128 v[160:163], v100 offset:0
    ds_read_b128 v[164:167], v101 offset:0
    ds_read_b128 v[168:171], v102 offset:0
    ds_read_b128 v[172:175], v103 offset:0
    s_barrier
    ds_read_b64_tr_b16 v[64:65], v1 offset:8192
    ds_read_b64_tr_b16 v[66:67], v1 offset:8448
    ds_read_b64_tr_b16 v[68:69], v1 offset:9216
    ds_read_b64_tr_b16 v[70:71], v1 offset:9472
    ds_read_b64_tr_b16 v[72:73], v1 offset:10240
    ds_read_b64_tr_b16 v[74:75], v1 offset:10496
    ds_read_b64_tr_b16 v[76:77], v1 offset:11264
    ds_read_b64_tr_b16 v[78:79], v1 offset:11520
    v_mfma_f32_32x32x16_bf16 v[16:31], v[32:35], v[144:147], v[16:31]
    s_waitcnt lgkmcnt(8)
    v_mfma_f32_32x32x16_bf16 v[16:31], v[36:39], v[148:151], v[16:31]
    s_add_u32 m0, s38, 32768
    s_nop 0
    buffer_load_dwordx4 v96, s[8:11], s45 offen  lds
    v_mfma_f32_32x32x16_bf16 v[16:31], v[40:43], v[152:155], v[16:31]
    s_add_u32 m0, s38, 33792
    s_nop 0
    buffer_load_dwordx4 v97, s[8:11], s45 offen  lds
    s_add_u32 m0, s38, 34816
    s_nop 0
    buffer_load_dwordx4 v98, s[8:11], s45 offen  lds
    v_mfma_f32_32x32x16_bf16 v[16:31], v[44:47], v[156:159], v[16:31]
    s_add_u32 m0, s38, 35840
    s_nop 0
    buffer_load_dwordx4 v99, s[8:11], s45 offen  lds
    s_add_u32 m0, s37, 20480
    s_nop 0
    buffer_load_dwordx4 v3, s[12:15], s53 offen  lds
    s_waitcnt vmcnt(10)
    ds_read_b128 v[176:179], v100 offset:16384
    ds_read_b128 v[180:183], v101 offset:16384
    ds_read_b128 v[184:187], v102 offset:16384
    ds_read_b128 v[188:191], v103 offset:16384
    s_barrier
    ds_read_b64_tr_b16 v[32:33], v1 offset:12288
    ds_read_b64_tr_b16 v[34:35], v1 offset:12544
    ds_read_b64_tr_b16 v[36:37], v1 offset:13312
    ds_read_b64_tr_b16 v[38:39], v1 offset:13568
    ds_read_b64_tr_b16 v[40:41], v1 offset:14336
    ds_read_b64_tr_b16 v[42:43], v1 offset:14592
    ds_read_b64_tr_b16 v[44:45], v1 offset:15360
    ds_read_b64_tr_b16 v[46:47], v1 offset:15616
    s_waitcnt lgkmcnt(14)
    v_mfma_f32_32x32x16_bf16 v[16:31], v[64:67], v[160:163], v[16:31]
    s_waitcnt lgkmcnt(8)
    v_mfma_f32_32x32x16_bf16 v[16:31], v[68:71], v[164:167], v[16:31]
    s_add_u32 m0, s38, 49152
    s_nop 0
    buffer_load_dwordx4 v96, s[8:11], s46 offen  lds
    v_mfma_f32_32x32x16_bf16 v[16:31], v[72:75], v[168:171], v[16:31]
    s_add_u32 m0, s38, 50176
    s_nop 0
    buffer_load_dwordx4 v97, s[8:11], s46 offen  lds
    s_add_u32 m0, s38, 51200
    s_nop 0
    buffer_load_dwordx4 v98, s[8:11], s46 offen  lds
    v_mfma_f32_32x32x16_bf16 v[16:31], v[76:79], v[172:175], v[16:31]
    s_add_u32 m0, s38, 52224
    s_nop 0
    buffer_load_dwordx4 v99, s[8:11], s46 offen  lds
    s_add_u32 m0, s37, 24576
    s_nop 0
    buffer_load_dwordx4 v3, s[12:15], s54 offen  lds
    s_waitcnt vmcnt(10)
    ds_read_b128 v[192:195], v100 offset:32768
    ds_read_b128 v[196:199], v101 offset:32768
    ds_read_b128 v[200:203], v102 offset:32768
    ds_read_b128 v[204:207], v103 offset:32768
    s_barrier
    ds_read_b64_tr_b16 v[64:65], v1 offset:16384
    ds_read_b64_tr_b16 v[66:67], v1 offset:16640
    ds_read_b64_tr_b16 v[68:69], v1 offset:17408
    ds_read_b64_tr_b16 v[70:71], v1 offset:17664
    ds_read_b64_tr_b16 v[72:73], v1 offset:18432
    ds_read_b64_tr_b16 v[74:75], v1 offset:18688
    ds_read_b64_tr_b16 v[76:77], v1 offset:19456
    ds_read_b64_tr_b16 v[78:79], v1 offset:19712
    s_waitcnt lgkmcnt(14)
    v_mfma_f32_32x32x16_bf16 v[16:31], v[32:35], v[176:179], v[16:31]
    s_waitcnt lgkmcnt(8)
    v_mfma_f32_32x32x16_bf16 v[16:31], v[36:39], v[180:183], v[16:31]
    s_add_u32 m0, s38, 65536
    s_nop 0
    buffer_load_dwordx4 v96, s[8:11], s47 offen  lds
    v_mfma_f32_32x32x16_bf16 v[16:31], v[40:43], v[184:187], v[16:31]
    s_add_u32 m0, s38, 66560
    s_nop 0
    buffer_load_dwordx4 v97, s[8:11], s47 offen  lds
    s_add_u32 m0, s38, 67584
    s_nop 0
    buffer_load_dwordx4 v98, s[8:11], s47 offen  lds
    v_mfma_f32_32x32x16_bf16 v[16:31], v[44:47], v[188:191], v[16:31]
    s_add_u32 m0, s38, 68608
    s_nop 0
    buffer_load_dwordx4 v99, s[8:11], s47 offen  lds
    s_add_u32 m0, s37, 28672
    s_nop 0
    buffer_load_dwordx4 v3, s[12:15], s55 offen  lds
    s_waitcnt vmcnt(10)
    ds_read_b128 v[208:211], v100 offset:0
    ds_read_b128 v[212:215], v101 offset:0
    ds_read_b128 v[216:219], v102 offset:0
    ds_read_b128 v[220:223], v103 offset:0
    s_barrier
    ds_read_b64_tr_b16 v[32:33], v1 offset:20480
    ds_read_b64_tr_b16 v[34:35], v1 offset:20736
    ds_read_b64_tr_b16 v[36:37], v1 offset:21504
    ds_read_b64_tr_b16 v[38:39], v1 offset:21760
    ds_read_b64_tr_b16 v[40:41], v1 offset:22528
    ds_read_b64_tr_b16 v[42:43], v1 offset:22784
    ds_read_b64_tr_b16 v[44:45], v1 offset:23552
    ds_read_b64_tr_b16 v[46:47], v1 offset:23808
    s_waitcnt lgkmcnt(14)
    v_mfma_f32_32x32x16_bf16 v[16:31], v[64:67], v[192:195], v[16:31]
    s_waitcnt lgkmcnt(8)
    v_mfma_f32_32x32x16_bf16 v[16:31], v[68:71], v[196:199], v[16:31]
    s_add_u32 m0, s38, 31744
    s_nop 0
    buffer_load_dwordx4 v3, s[12:15], s48 offen offset:1024  lds
    v_mfma_f32_32x32x16_bf16 v[16:31], v[72:75], v[200:203], v[16:31]
    s_add_u32 m0, s38, 32768
    s_nop 0
    buffer_load_dwordx4 v3, s[12:15], s49 offen offset:1024  lds
    v_mfma_f32_32x32x16_bf16 v[16:31], v[76:79], v[204:207], v[16:31]
    s_add_u32 m0, s38, 33792
    s_nop 0
    buffer_load_dwordx4 v3, s[12:15], s50 offen offset:1024  lds
    s_add_u32 m0, s38, 34816
    s_nop 0
    buffer_load_dwordx4 v3, s[12:15], s51 offen offset:1024  lds
    s_waitcnt vmcnt(9)
    ds_read_b128 v[224:227], v100 offset:16384
    ds_read_b128 v[228:231], v101 offset:16384
    ds_read_b128 v[232:235], v102 offset:16384
    ds_read_b128 v[236:239], v103 offset:16384
    s_barrier
    ds_read_b64_tr_b16 v[64:65], v1 offset:24576
    ds_read_b64_tr_b16 v[66:67], v1 offset:24832
    ds_read_b64_tr_b16 v[68:69], v1 offset:25600
    ds_read_b64_tr_b16 v[70:71], v1 offset:25856
    ds_read_b64_tr_b16 v[72:73], v1 offset:26624
    ds_read_b64_tr_b16 v[74:75], v1 offset:26880
    ds_read_b64_tr_b16 v[76:77], v1 offset:27648
    ds_read_b64_tr_b16 v[78:79], v1 offset:27904
    s_waitcnt lgkmcnt(14)
    v_mfma_f32_32x32x16_bf16 v[16:31], v[32:35], v[208:211], v[16:31]
    s_waitcnt lgkmcnt(14)
    v_mfma_f32_32x32x16_bf16 v[16:31], v[36:39], v[212:215], v[16:31]
    s_waitcnt lgkmcnt(14)
    v_mfma_f32_32x32x16_bf16 v[16:31], v[40:43], v[216:219], v[16:31]
    s_waitcnt lgkmcnt(12)
    v_mfma_f32_32x32x16_bf16 v[16:31], v[44:47], v[220:223], v[16:31]
    s_waitcnt lgkmcnt(6)
    v_mfma_f32_32x32x16_bf16 v[16:31], v[64:67], v[224:227], v[16:31]
    s_waitcnt lgkmcnt(4)
    v_mfma_f32_32x32x16_bf16 v[16:31], v[68:71], v[228:231], v[16:31]
    s_waitcnt lgkmcnt(2)
    v_mfma_f32_32x32x16_bf16 v[16:31], v[72:75], v[232:235], v[16:31]
    s_waitcnt lgkmcnt(0)
    v_mfma_f32_32x32x16_bf16 v[16:31], v[76:79], v[236:239], v[16:31]
    s_waitcnt vmcnt(4)
    ds_read_b128 v[240:243], v100 offset:32768
    ds_read_b128 v[244:247], v101 offset:32768
    ds_read_b128 v[248:251], v102 offset:32768
    ds_read_b128 v[252:255], v103 offset:32768
    s_barrier
    ds_read_b64_tr_b16 v[32:33], v1 offset:28672
    ds_read_b64_tr_b16 v[34:35], v1 offset:28928
    ds_read_b64_tr_b16 v[36:37], v1 offset:29696
    ds_read_b64_tr_b16 v[38:39], v1 offset:29952
    ds_read_b64_tr_b16 v[40:41], v1 offset:30720
    ds_read_b64_tr_b16 v[42:43], v1 offset:30976
    ds_read_b64_tr_b16 v[44:45], v1 offset:31744
    ds_read_b64_tr_b16 v[46:47], v1 offset:32000
    s_waitcnt lgkmcnt(6)
    v_mfma_f32_32x32x16_bf16 v[16:31], v[32:35], v[240:243], v[16:31]
    s_waitcnt lgkmcnt(4)
    v_mfma_f32_32x32x16_bf16 v[16:31], v[36:39], v[244:247], v[16:31]
    s_waitcnt lgkmcnt(2)
    v_mfma_f32_32x32x16_bf16 v[16:31], v[40:43], v[248:251], v[16:31]
    s_waitcnt lgkmcnt(0)
    v_mfma_f32_32x32x16_bf16 v[16:31], v[44:47], v[252:255], v[16:31]
    s_add_u32 m0, s38, 48128
    s_nop 0
    buffer_load_dwordx4 v3, s[12:15], s52 offen offset:1024  lds
    s_add_u32 m0, s38, 49152
    s_nop 0
    buffer_load_dwordx4 v3, s[12:15], s53 offen offset:1024  lds
    s_add_u32 m0, s38, 50176
    s_nop 0
    buffer_load_dwordx4 v3, s[12:15], s54 offen offset:1024  lds
    s_add_u32 m0, s38, 51200
    s_nop 0
    buffer_load_dwordx4 v3, s[12:15], s55 offen offset:1024  lds
    s_setprio 2
    v_cvt_pk_bf16_f32 v96, v16, v17
    v_cvt_pk_bf16_f32 v97, v18, v19
    v_cvt_pk_bf16_f32 v98, v20, v21
    v_cvt_pk_bf16_f32 v99, v22, v23
    v_cvt_pk_bf16_f32 v100, v24, v25
    v_cvt_pk_bf16_f32 v101, v26, v27
    v_mfma_f32_32x32x16_bf16 v[48:63], v[8:11], v[96:99], 0
    v_cvt_pk_bf16_f32 v102, v28, v29
    v_cvt_pk_bf16_f32 v103, v30, v31
    s_nop 1
    v_mfma_f32_32x32x16_bf16 v[48:63], v[12:15], v[100:103], v[48:63]
    s_waitcnt vmcnt(6)
    s_barrier
    v_subrev_u32 v3, 1024, v3
    ds_read_b64_tr_b16 v[64:65], v2 offset:32768
    ds_read_b64_tr_b16 v[66:67], v2 offset:33024
    ds_read_b64_tr_b16 v[68:69], v2 offset:36864
    ds_read_b64_tr_b16 v[70:71], v2 offset:37120
    ds_read_b64_tr_b16 v[72:73], v2 offset:40960
    ds_read_b64_tr_b16 v[74:75], v2 offset:41216
    ds_read_b64_tr_b16 v[76:77], v2 offset:45056
    ds_read_b64_tr_b16 v[78:79], v2 offset:45312
    ds_read_b64_tr_b16 v[80:81], v2 offset:33792
    ds_read_b64_tr_b16 v[82:83], v2 offset:34048
    v_max3_f32 v6, v48, v49, v50
    v_min3_f32 v7, v48, v49, v50
    v_max3_f32 v6, v6, v51, v52
    v_min3_f32 v7, v7, v51, v52
    v_max3_f32 v6, v6, v53, v54
    v_min3_f32 v7, v7, v53, v54
    v_max3_f32 v6, v6, v55, v56
    v_min3_f32 v7, v7, v55, v56
    s_waitcnt lgkmcnt(8)
    v_mfma_f32_32x32x16_bf16 v[32:47], v[64:67], v[128:131], 0
    ds_read_b64_tr_b16 v[84:85], v2 offset:37888
    ds_read_b64_tr_b16 v[86:87], v2 offset:38144
    v_max3_f32 v6, v6, v57, v58
    v_min3_f32 v7, v7, v57, v58
    v_max3_f32 v6, v6, v59, v60
    v_min3_f32 v7, v7, v59, v60
    v_max3_f32 v6, v6, v61, v62
    v_min3_f32 v7, v7, v61, v62
    s_waitcnt lgkmcnt(8)
    v_mfma_f32_32x32x16_bf16 v[32:47], v[68:71], v[132:135], v[32:47]
    ds_read_b64_tr_b16 v[64:65], v2 offset:41984
    ds_read_b64_tr_b16 v[66:67], v2 offset:42240
    v_max_f32 v6, v6, v63
    v_min_f32 v7, v7, v63
    v_mul_f32 v6, 0xbfb8aa3b, v6
    v_mul_f32 v7, 0x3fb8aa3b, v7
    v_fma_f32 v96, v48, s64, v6
    v_fma_f32 v97, v49, s64, v6
    s_waitcnt lgkmcnt(8)
    v_mfma_f32_32x32x16_bf16 v[32:47], v[72:75], v[136:139], v[32:47]
    ds_read_b64_tr_b16 v[68:69], v2 offset:46080
    ds_read_b64_tr_b16 v[70:71], v2 offset:46336
    v_fma_f32 v98, v50, s64, v6
    v_exp_f32 v96, v96
    v_fma_f32 v99, v51, s64, v6
    v_exp_f32 v97, v97
    s_add_u32 m0, s37, 0
    s_nop 0
    buffer_load_dwordx4 v3, s[12:15], s48 offen  lds
    s_waitcnt lgkmcnt(8)
    v_mfma_f32_32x32x16_bf16 v[32:47], v[76:79], v[140:143], v[32:47]
    s_waitcnt vmcnt(5)
    s_barrier
    ds_read_b64_tr_b16 v[72:73], v2 offset:34816
    ds_read_b64_tr_b16 v[74:75], v2 offset:35072
    v_fma_f32 v100, v52, s64, v6
    v_exp_f32 v98, v98
    v_fma_f32 v101, v53, s64, v6
    v_exp_f32 v99, v99
    s_waitcnt lgkmcnt(8)
    v_mfma_f32_32x32x16_bf16 v[32:47], v[80:83], v[144:147], v[32:47]
    ds_read_b64_tr_b16 v[76:77], v2 offset:38912
    ds_read_b64_tr_b16 v[78:79], v2 offset:39168
    v_fma_f32 v102, v54, s64, v6
    v_exp_f32 v100, v100
    v_fma_f32 v103, v55, s64, v6
    v_exp_f32 v101, v101
    s_add_u32 m0, s37, 4096
    s_nop 0
    buffer_load_dwordx4 v3, s[12:15], s49 offen  lds
    s_waitcnt lgkmcnt(8)
    v_mfma_f32_32x32x16_bf16 v[32:47], v[84:87], v[148:151], v[32:47]
    ds_read_b64_tr_b16 v[80:81], v2 offset:43008
    ds_read_b64_tr_b16 v[82:83], v2 offset:43264
    v_fma_f32 v104, v56, s64, v6
    v_exp_f32 v102, v102
    v_fma_f32 v105, v57, s64, v6
    v_exp_f32 v103, v103
    v_fma_f32 v106, v58, s64, v6
    s_waitcnt lgkmcnt(8)
    v_mfma_f32_32x32x16_bf16 v[32:47], v[64:67], v[152:155], v[32:47]
    ds_read_b64_tr_b16 v[84:85], v2 offset:47104
    ds_read_b64_tr_b16 v[86:87], v2 offset:47360
    v_exp_f32 v104, v104
    v_fma_f32 v107, v59, s64, v6
    v_exp_f32 v105, v105
    v_fma_f32 v108, v60, s64, v6
    s_add_u32 m0, s37, 8192
    s_nop 0
    buffer_load_dwordx4 v3, s[12:15], s50 offen  lds
    s_waitcnt lgkmcnt(8)
    v_mfma_f32_32x32x16_bf16 v[32:47], v[68:71], v[156:159], v[32:47]
    ds_read_b64_tr_b16 v[64:65], v2 offset:35840
    ds_read_b64_tr_b16 v[66:67], v2 offset:36096
    v_exp_f32 v106, v106
    v_fma_f32 v109, v61, s64, v6
    v_exp_f32 v107, v107
    v_fma_f32 v110, v62, s64, v6
    s_waitcnt lgkmcnt(8)
    v_mfma_f32_32x32x16_bf16 v[32:47], v[72:75], v[160:163], v[32:47]
    ds_read_b64_tr_b16 v[68:69], v2 offset:39936
    ds_read_b64_tr_b16 v[70:71], v2 offset:40192
    v_exp_f32 v108, v108
    v_fma_f32 v111, v63, s64, v6
    v_exp_f32 v109, v109
    v_fma_f32 v112, v48, -s64, v7
    s_add_u32 m0, s37, 12288
    s_nop 0
    buffer_load_dwordx4 v3, s[12:15], s51 offen  lds
    s_waitcnt lgkmcnt(8)
    v_mfma_f32_32x32x16_bf16 v[32:47], v[76:79], v[164:167], v[32:47]
    ds_read_b64_tr_b16 v[72:73], v2 offset:44032
    ds_read_b64_tr_b16 v[74:75], v2 offset:44288
    v_exp_f32 v110, v110
    v_fma_f32 v113, v49, -s64, v7
    v_exp_f32 v111, v111
    v_fma_f32 v114, v50, -s64, v7
    s_waitcnt lgkmcnt(8)
    v_mfma_f32_32x32x16_bf16 v[32:47], v[80:83], v[168:171], v[32:47]
    ds_read_b64_tr_b16 v[76:77], v2 offset:48128
    ds_read_b64_tr_b16 v[78:79], v2 offset:48384
    v_exp_f32 v112, v112
    v_fma_f32 v115, v51, -s64, v7
    v_exp_f32 v113, v113
    v_fma_f32 v116, v52, -s64, v7
    s_add_u32 m0, s37, 16384
    s_nop 0
    buffer_load_dwordx4 v3, s[12:15], s52 offen  lds
    s_waitcnt lgkmcnt(8)
    v_mfma_f32_32x32x16_bf16 v[32:47], v[84:87], v[172:175], v[32:47]
    s_waitcnt vmcnt(7)
    s_barrier
    ds_read_b64_tr_b16 v[80:81], v2 offset:49152
    ds_read_b64_tr_b16 v[82:83], v2 offset:49408
    v_exp_f32 v114, v114
    v_fma_f32 v117, v53, -s64, v7
    v_exp_f32 v115, v115
    v_fma_f32 v118, v54, -s64, v7
    s_waitcnt lgkmcnt(8)
    v_mfma_f32_32x32x16_bf16 v[32:47], v[64:67], v[176:179], v[32:47]
    ds_read_b64_tr_b16 v[84:85], v2 offset:53248
    ds_read_b64_tr_b16 v[86:87], v2 offset:53504
    v_exp_f32 v116, v116
    v_fma_f32 v119, v55, -s64, v7
    v_exp_f32 v117, v117
    v_fma_f32 v120, v56, -s64, v7
    s_add_u32 m0, s37, 20480
    s_nop 0
    buffer_load_dwordx4 v3, s[12:15], s53 offen  lds
    s_waitcnt lgkmcnt(8)
    v_mfma_f32_32x32x16_bf16 v[32:47], v[68:71], v[180:183], v[32:47]
    ds_read_b64_tr_b16 v[64:65], v2 offset:57344
    ds_read_b64_tr_b16 v[66:67], v2 offset:57600
    v_exp_f32 v118, v118
    v_fma_f32 v121, v57, -s64, v7
    v_exp_f32 v119, v119
    v_fma_f32 v122, v58, -s64, v7
    s_waitcnt lgkmcnt(8)
    v_mfma_f32_32x32x16_bf16 v[32:47], v[72:75], v[184:187], v[32:47]
    ds_read_b64_tr_b16 v[68:69], v2 offset:61440
    ds_read_b64_tr_b16 v[70:71], v2 offset:61696
    v_exp_f32 v120, v120
    v_fma_f32 v123, v59, -s64, v7
    v_exp_f32 v121, v121
    v_fma_f32 v124, v60, -s64, v7
    s_add_u32 m0, s37, 24576
    s_nop 0
    buffer_load_dwordx4 v3, s[12:15], s54 offen  lds
    s_waitcnt lgkmcnt(8)
    v_mfma_f32_32x32x16_bf16 v[32:47], v[76:79], v[188:191], v[32:47]
    ds_read_b64_tr_b16 v[72:73], v2 offset:50176
    ds_read_b64_tr_b16 v[74:75], v2 offset:50432
    v_exp_f32 v122, v122
    v_fma_f32 v125, v61, -s64, v7
    v_exp_f32 v123, v123
    v_fma_f32 v126, v62, -s64, v7
    s_waitcnt lgkmcnt(8)
    v_mfma_f32_32x32x16_bf16 v[32:47], v[80:83], v[192:195], v[32:47]
    ds_read_b64_tr_b16 v[76:77], v2 offset:54272
    ds_read_b64_tr_b16 v[78:79], v2 offset:54528
    v_exp_f32 v124, v124
    v_fma_f32 v127, v63, -s64, v7
    v_exp_f32 v125, v125
    v_exp_f32 v126, v126
    s_add_u32 m0, s37, 28672
    s_nop 0
    buffer_load_dwordx4 v3, s[12:15], s55 offen  lds
    s_waitcnt lgkmcnt(8)
    v_mfma_f32_32x32x16_bf16 v[32:47], v[84:87], v[196:199], v[32:47]
    ds_read_b64_tr_b16 v[80:81], v2 offset:58368
    ds_read_b64_tr_b16 v[82:83], v2 offset:58624
    v_exp_f32 v127, v127
    v_add_f32 v48, v96, v100
    v_add_f32 v49, v97, v101
    v_add_f32 v50, v98, v102
    v_add_f32 v51, v99, v103
    s_waitcnt lgkmcnt(8)
    v_mfma_f32_32x32x16_bf16 v[32:47], v[64:67], v[200:203], v[32:47]
    ds_read_b64_tr_b16 v[84:85], v2 offset:62464
    ds_read_b64_tr_b16 v[86:87], v2 offset:62720
    v_add_f32 v52, v112, v116
    v_add_f32 v53, v113, v117
    v_add_f32 v54, v114, v118
    v_add_f32 v55, v115, v119
    v_add_f32 v48, v48, v104
    v_add_f32 v49, v49, v105
    v_bfe_u32 v5, v0, 3, 1
    v_lshlrev_b32 v5, 4, v5
    v_and_or_b32 v5, v0, 7, v5
    s_waitcnt lgkmcnt(8)
    v_mfma_f32_32x32x16_bf16 v[32:47], v[68:71], v[204:207], v[32:47]
    s_waitcnt vmcnt(8)
    s_barrier
    ds_read_b64_tr_b16 v[64:65], v2 offset:51200
    ds_read_b64_tr_b16 v[66:67], v2 offset:51456
    v_add_f32 v50, v50, v106
    v_add_f32 v51, v51, v107
    v_add_f32 v52, v52, v120
    v_add_f32 v53, v53, v121
    v_add_f32 v54, v54, v122
    v_add_f32 v55, v55, v123
    v_lshlrev_b32 v5, 7, v5
    buffer_load_dword v5, v5, s[24:27], s65 offen
    s_waitcnt lgkmcnt(8)
    v_mfma_f32_32x32x16_bf16 v[32:47], v[72:75], v[208:211], v[32:47]
    ds_read_b64_tr_b16 v[68:69], v2 offset:55296
    ds_read_b64_tr_b16 v[70:71], v2 offset:55552
    v_add_f32 v48, v48, v108
    v_add_f32 v49, v49, v109
    v_add_f32 v50, v50, v110
    v_add_f32 v51, v51, v111
    v_add_f32 v52, v52, v124
    v_add_f32 v53, v53, v125
    s_waitcnt lgkmcnt(8)
    v_mfma_f32_32x32x16_bf16 v[32:47], v[76:79], v[212:215], v[32:47]
    ds_read_b64_tr_b16 v[72:73], v2 offset:59392
    ds_read_b64_tr_b16 v[74:75], v2 offset:59648
    v_add_f32 v54, v54, v126
    v_add_f32 v55, v55, v127
    v_add_f32 v48, v48, v50
    v_add_f32 v49, v49, v51
    v_add_f32 v52, v52, v54
    v_add_f32 v53, v53, v55
    s_waitcnt lgkmcnt(8)
    v_mfma_f32_32x32x16_bf16 v[32:47], v[80:83], v[216:219], v[32:47]
    ds_read_b64_tr_b16 v[76:77], v2 offset:63488
    ds_read_b64_tr_b16 v[78:79], v2 offset:63744
    v_add_f32 v48, v48, v49
    v_add_f32 v52, v52, v53
    v_rcp_f32 v6, v48
    v_rcp_f32 v7, v52
    s_waitcnt lgkmcnt(8)
    v_mfma_f32_32x32x16_bf16 v[32:47], v[84:87], v[220:223], v[32:47]
    ds_read_b64_tr_b16 v[80:81], v2 offset:52224
    ds_read_b64_tr_b16 v[82:83], v2 offset:52480
    v_xor_b32 v57, 16, v88
    v_xor_b32 v58, 32, v88
    v_xor_b32 v59, 48, v88
    v_mul_f32 v96, v96, v6
    v_mul_f32 v97, v97, v6
    v_mul_f32 v98, v98, v6
    s_waitcnt lgkmcnt(8)
    v_mfma_f32_32x32x16_bf16 v[32:47], v[64:67], v[224:227], v[32:47]
    ds_read_b64_tr_b16 v[84:85], v2 offset:56320
    ds_read_b64_tr_b16 v[86:87], v2 offset:56576
    v_mul_f32 v99, v99, v6
    v_mul_f32 v100, v100, v6
    v_mul_f32 v101, v101, v6
    v_mul_f32 v102, v102, v6
    v_mul_f32 v103, v103, v6
    v_cvt_pk_bf16_f32 v16, v96, v97
    s_waitcnt lgkmcnt(8)
    v_mfma_f32_32x32x16_bf16 v[32:47], v[68:71], v[228:231], v[32:47]
    ds_read_b64_tr_b16 v[64:65], v2 offset:60416
    ds_read_b64_tr_b16 v[66:67], v2 offset:60672
    v_cvt_pk_bf16_f32 v17, v98, v99
    v_cvt_pk_bf16_f32 v18, v100, v101
    v_cvt_pk_bf16_f32 v19, v102, v103
    ds_write_b128 v88, v[16:19]
    v_mul_f32 v104, v104, v6
    v_mul_f32 v105, v105, v6
    s_waitcnt lgkmcnt(9)
    v_mfma_f32_32x32x16_bf16 v[32:47], v[72:75], v[232:235], v[32:47]
    ds_read_b64_tr_b16 v[68:69], v2 offset:64512
    ds_read_b64_tr_b16 v[70:71], v2 offset:64768
    v_mul_f32 v106, v106, v6
    v_mul_f32 v107, v107, v6
    v_mul_f32 v108, v108, v6
    v_mul_f32 v109, v109, v6
    v_mul_f32 v110, v110, v6
    v_mul_f32 v111, v111, v6
    v_cvt_pk_bf16_f32 v20, v104, v105
    s_waitcnt lgkmcnt(9)
    v_mfma_f32_32x32x16_bf16 v[32:47], v[76:79], v[236:239], v[32:47]
    v_cvt_pk_bf16_f32 v21, v106, v107
    v_cvt_pk_bf16_f32 v22, v108, v109
    v_cvt_pk_bf16_f32 v23, v110, v111
    ds_write_b128 v57, v[20:23]
    v_mul_f32 v112, v112, v7
    v_mul_f32 v113, v113, v7
    s_waitcnt lgkmcnt(8)
    v_mfma_f32_32x32x16_bf16 v[32:47], v[80:83], v[240:243], v[32:47]
    v_mul_f32 v114, v114, v7
    v_mul_f32 v115, v115, v7
    v_mul_f32 v116, v116, v7
    v_mul_f32 v117, v117, v7
    v_mul_f32 v118, v118, v7
    v_mul_f32 v119, v119, v7
    s_waitcnt lgkmcnt(6)
    v_mfma_f32_32x32x16_bf16 v[32:47], v[84:87], v[244:247], v[32:47]
    v_cvt_pk_bf16_f32 v24, v112, v113
    v_cvt_pk_bf16_f32 v25, v114, v115
    v_cvt_pk_bf16_f32 v26, v116, v117
    v_cvt_pk_bf16_f32 v27, v118, v119
    ds_write_b128 v58, v[24:27]
    v_mul_f32 v120, v120, v7
    s_waitcnt lgkmcnt(5)
    v_mfma_f32_32x32x16_bf16 v[32:47], v[64:67], v[248:251], v[32:47]
    v_mul_f32 v121, v121, v7
    v_mul_f32 v122, v122, v7
    v_mul_f32 v123, v123, v7
    v_mul_f32 v124, v124, v7
    v_mul_f32 v125, v125, v7
    v_mul_f32 v126, v126, v7
    s_waitcnt lgkmcnt(2)
    v_mfma_f32_32x32x16_bf16 v[32:47], v[68:71], v[252:255], v[32:47]
    v_mul_f32 v127, v127, v7
    v_cvt_pk_bf16_f32 v28, v120, v121
    v_cvt_pk_bf16_f32 v29, v122, v123
    v_cvt_pk_bf16_f32 v30, v124, v125
    v_cvt_pk_bf16_f32 v31, v126, v127
    ds_write_b128 v59, v[28:31]
    v_mov_b32 v48, 0x3f803f80
    v_mov_b32 v49, 0x3f803f80
    v_mov_b32 v50, 0x3f803f80
    v_mov_b32 v51, 0x3f803f80
    v_xor_b32 v52, 16, v89
    s_nop 0
    v_cvt_pk_bf16_f32 v96, v32, v33
    v_cvt_pk_bf16_f32 v97, v34, v35
    v_cvt_pk_bf16_f32 v98, v36, v37
    v_cvt_pk_bf16_f32 v99, v38, v39
    ds_write_b128 v89, v[96:99]
    v_cvt_pk_bf16_f32 v100, v40, v41
    v_cvt_pk_bf16_f32 v101, v42, v43
    v_cvt_pk_bf16_f32 v102, v44, v45
    v_cvt_pk_bf16_f32 v103, v46, v47
    ds_write_b128 v52, v[100:103]
    s_waitcnt lgkmcnt(0)
    s_barrier
    ds_read_b64_tr_b16 v[16:17], v90 offset:0
    ds_read_b64_tr_b16 v[18:19], v90 offset:1024
    ds_read_b64_tr_b16 v[20:21], v91 offset:0
    ds_read_b64_tr_b16 v[22:23], v91 offset:512
    ds_read_b64_tr_b16 v[24:25], v90 offset:4096
    ds_read_b64_tr_b16 v[26:27], v90 offset:5120
    ds_read_b64_tr_b16 v[28:29], v91 offset:4096
    ds_read_b64_tr_b16 v[30:31], v91 offset:4608
    ds_read_b64_tr_b16 v[32:33], v90 offset:8192
    ds_read_b64_tr_b16 v[34:35], v90 offset:9216
    ds_read_b64_tr_b16 v[36:37], v91 offset:8192
    ds_read_b64_tr_b16 v[38:39], v91 offset:8704
    ds_read_b64_tr_b16 v[40:41], v90 offset:12288
    ds_read_b64_tr_b16 v[42:43], v90 offset:13312
    ds_read_b64_tr_b16 v[44:45], v91 offset:12288
    ds_read_b64_tr_b16 v[46:47], v91 offset:12800
    s_waitcnt lgkmcnt(14)
    v_mfma_f32_16x16x32_bf16 v[60:63], v[16:19], v[48:51], 0
    s_waitcnt lgkmcnt(12)
    v_mfma_f32_16x16x32_bf16 v[56:59], v[16:19], v[20:23], 0
    s_waitcnt lgkmcnt(10)
    v_mfma_f32_16x16x32_bf16 v[60:63], v[24:27], v[48:51], v[60:63]
    s_waitcnt lgkmcnt(8)
    v_mfma_f32_16x16x32_bf16 v[56:59], v[24:27], v[28:31], v[56:59]
    s_waitcnt lgkmcnt(6)
    v_mfma_f32_16x16x32_bf16 v[60:63], v[32:35], v[48:51], v[60:63]
    s_waitcnt lgkmcnt(4)
    v_mfma_f32_16x16x32_bf16 v[56:59], v[32:35], v[36:39], v[56:59]
    s_waitcnt lgkmcnt(2)
    v_mfma_f32_16x16x32_bf16 v[60:63], v[40:43], v[48:51], v[60:63]
    s_waitcnt lgkmcnt(0)
    v_mfma_f32_16x16x32_bf16 v[56:59], v[40:43], v[44:47], v[56:59]
    s_mov_b32 s69, 0
    s_mov_b32 s68, 0
    s_nop 3
    v_cvt_pk_bf16_f32 v106, v60, v61
    v_cvt_pk_bf16_f32 v107, v62, v63
    v_cvt_pk_bf16_f32 v104, v56, v57
    v_cvt_pk_bf16_f32 v105, v58, v59
    s_nop 0
    v_permlane32_swap_b32 v104, v106
    v_permlane32_swap_b32 v105, v107
    v_and_or_b32 v104, v104, v93, s56
    v_and_or_b32 v105, v105, v93, s57
    v_and_or_b32 v106, v106, v93, s58
    v_and_or_b32 v107, v107, v93, s59
    s_mov_b32 exec_hi, 0x000f000f
    buffer_store_dwordx4 v[104:107], v92, s[28:31], s39 offen sc1
    s_mov_b32 exec_hi, -1
    s_waitcnt vmcnt(2)
    s_barrier
    s_cmp_lg_u32 s34, 0
    s_cbranch_scc1 B_NOBF
    v_mov_b32 v108, s60
    v_mov_b32 v109, s77
    v_mov_b32 v110, 0
    s_lshl_b32 s61, s36, 5
    s_add_u32 s61, s61, s35
    s_lshl_b32 s61, s61, 4
    s_add_u32 s61, s61, 655360
    s_mov_b64 exec, 1
    buffer_store_dwordx2 v[108:109], v110, s[28:31], s61 offen sc1
    s_mov_b64 exec, -1
B_NOBF:
    ds_read_b64_tr_b16 v[64:65], v1 offset:0
    ds_read_b64_tr_b16 v[66:67], v1 offset:256
    ds_read_b64_tr_b16 v[68:69], v1 offset:1024
    ds_read_b64_tr_b16 v[70:71], v1 offset:1280
    ds_read_b64_tr_b16 v[72:73], v1 offset:2048
    ds_read_b64_tr_b16 v[74:75], v1 offset:2304
    ds_read_b64_tr_b16 v[76:77], v1 offset:3072
    ds_read_b64_tr_b16 v[78:79], v1 offset:3328
    ds_read_b64_tr_b16 v[80:81], v1 offset:4096
    ds_read_b64_tr_b16 v[82:83], v1 offset:4352
    s_waitcnt lgkmcnt(8)
    v_mfma_f32_32x32x16_bf16 v[16:31], v[64:67], v[128:131], 0
    ds_read_b64_tr_b16 v[84:85], v1 offset:5120
    ds_read_b64_tr_b16 v[86:87], v1 offset:5376
    v_bfe_u32 v45, v0, 4, 1
    v_lshlrev_b32 v45, 2, v45
    v_and_b32 v46, 7, v0
    v_xor_b32 v45, v45, v46
    v_lshlrev_b32 v45, 4, v45
    v_lshrrev_b32 v46, 3, v0
    v_lshl_add_u32 v45, v46, 10, v45
    s_lshl_b32 s62, s75, 7
    v_add_u32 v3, s62, v45
    s_waitcnt lgkmcnt(8)
    v_mfma_f32_32x32x16_bf16 v[16:31], v[68:71], v[132:135], v[16:31]
    ds_read_b64_tr_b16 v[64:65], v1 offset:6144
    ds_read_b64_tr_b16 v[66:67], v1 offset:6400
    s_add_u32 s40, s75, 0
    s_and_b32 s40, s40, 7
    s_add_u32 s41, s75, 1
    s_and_b32 s41, s41, 7
    s_add_u32 s42, s75, 2
    s_and_b32 s42, s42, 7
    s_add_u32 s43, s75, 3
    s_and_b32 s43, s43, 7
    s_add_u32 s44, s75, 4
    s_and_b32 s44, s44, 7
    s_add_u32 s45, s75, 5
    s_and_b32 s45, s45, 7
    s_add_u32 s46, s75, 6
    s_and_b32 s46, s46, 7
    s_add_u32 s47, s75, 7
    s_and_b32 s47, s47, 7
    s_waitcnt lgkmcnt(8)
    v_mfma_f32_32x32x16_bf16 v[16:31], v[72:75], v[136:139], v[16:31]
    ds_read_b64_tr_b16 v[68:69], v1 offset:7168
    ds_read_b64_tr_b16 v[70:71], v1 offset:7424
    s_lshl_b32 s3, s40, 15
    s_add_u32 m0, s37, 32768
    s_nop 0
    buffer_load_dwordx4 v3, s[20:23], s3 offen lds
    s_mul_i32 s61, s5, 1600
    s_mul_i32 s62, s4, 80
    s_add_u32 s61, s61, s62
    s_add_u32 s63, s61, 66816
    s_waitcnt lgkmcnt(8)
    v_mfma_f32_32x32x16_bf16 v[16:31], v[76:79], v[140:143], v[16:31]
    ds_read_b64_tr_b16 v[72:73], v1 offset:8192
    ds_read_b64_tr_b16 v[74:75], v1 offset:8448
    s_lshl_b32 s3, s41, 15
    s_add_u32 m0, s37, 36864
    s_nop 0
    buffer_load_dwordx4 v3, s[20:23], s3 offen lds
    v_bfe_u32 v98, v0, 2, 4
    v_mul_u32_u24 v98, 160, v98
    v_add_u32 v98, s63, v98
    s_waitcnt lgkmcnt(8)
    v_mfma_f32_32x32x16_bf16 v[16:31], v[80:83], v[144:147], v[16:31]
    ds_read_b64_tr_b16 v[76:77], v1 offset:9216
    ds_read_b64_tr_b16 v[78:79], v1 offset:9472
    s_mov_b64 s[66:67], 0xf00
    v_mov_b32 v100, 68736
    v_cndmask_b32 v98, v98, v100, s[66:67]
    s_waitcnt lgkmcnt(8)
    v_mfma_f32_32x32x16_bf16 v[16:31], v[84:87], v[148:151], v[16:31]
    ds_read_b64_tr_b16 v[80:81], v1 offset:10240
    ds_read_b64_tr_b16 v[82:83], v1 offset:10496
    s_lshl_b32 s3, s42, 15
    s_add_u32 m0, s37, 40960
    s_nop 0
    buffer_load_dwordx4 v3, s[20:23], s3 offen lds
    v_and_b32 v100, 3, v0
    v_lshl_add_u32 v98, v100, 4, v98
    s_lshl_b32 s62, s4, 1
    s_waitcnt lgkmcnt(8)
    v_mfma_f32_32x32x16_bf16 v[16:31], v[64:67], v[152:155], v[16:31]
    ds_read_b64_tr_b16 v[84:85], v1 offset:11264
    ds_read_b64_tr_b16 v[86:87], v1 offset:11520
    s_lshl_b32 s3, s43, 15
    s_add_u32 m0, s37, 45056
    s_nop 0
    buffer_load_dwordx4 v3, s[20:23], s3 offen lds
    s_lshl_b32 s66, 3, s62
    v_mov_b32 v101, 0x3f803f80
    v_cndmask_b32 v100, 0, v101, s[66:67]
    s_waitcnt lgkmcnt(8)
    v_mfma_f32_32x32x16_bf16 v[16:31], v[68:71], v[156:159], v[16:31]
    ds_read_b64_tr_b16 v[64:65], v1 offset:12288
    ds_read_b64_tr_b16 v[66:67], v1 offset:12544
    v_mov_b32 v101, v100
    v_mov_b32 v102, v100
    s_waitcnt lgkmcnt(8)
    v_mfma_f32_32x32x16_bf16 v[16:31], v[72:75], v[160:163], v[16:31]
    ds_read_b64_tr_b16 v[68:69], v1 offset:13312
    ds_read_b64_tr_b16 v[70:71], v1 offset:13568
    v_mov_b32 v103, v100
    s_mov_b64 exec, 0xfff
    ds_write_b128 v98, v[100:103]
    s_mov_b64 exec, -1
    v_and_b32 v45, 1, v0
    s_waitcnt lgkmcnt(9)
    v_mfma_f32_32x32x16_bf16 v[16:31], v[76:79], v[164:167], v[16:31]
    ds_read_b64_tr_b16 v[72:73], v1 offset:14336
    ds_read_b64_tr_b16 v[74:75], v1 offset:14592
    v_lshlrev_b32 v45, 4, v45
    v_mov_b32 v46, 0x3f80
    v_lshlrev_b32 v45, v45, v46
    s_waitcnt lgkmcnt(9)
    v_mfma_f32_32x32x16_bf16 v[16:31], v[80:83], v[168:171], v[16:31]
    ds_read_b64_tr_b16 v[76:77], v1 offset:15360
    ds_read_b64_tr_b16 v[78:79], v1 offset:15616
    v_bfe_u32 v46, v0, 1, 3
    v_cmp_eq_u32 s[66:67], 0, v46
    buffer_load_dwordx4 v[160:163], v95, s[28:31], s70 offen sc1
    s_waitcnt lgkmcnt(9)
    v_mfma_f32_32x32x16_bf16 v[16:31], v[84:87], v[172:175], v[16:31]
    ds_read_b64_tr_b16 v[80:81], v1 offset:16384
    ds_read_b64_tr_b16 v[82:83], v1 offset:16640
    v_cmp_eq_u32 s[6:7], 1, v46
    s_nop 0
    v_cndmask_b32 v32, 0, v45, s[66:67]
    s_waitcnt lgkmcnt(9)
    v_mfma_f32_32x32x16_bf16 v[16:31], v[64:67], v[176:179], v[16:31]
    ds_read_b64_tr_b16 v[84:85], v1 offset:17408
    ds_read_b64_tr_b16 v[86:87], v1 offset:17664
    v_cndmask_b32 v33, 0, v45, s[6:7]
    v_cmp_eq_u32 s[66:67], 2, v46
    v_cmp_eq_u32 s[6:7], 3, v46
    s_waitcnt lgkmcnt(9)
    v_mfma_f32_32x32x16_bf16 v[16:31], v[68:71], v[180:183], v[16:31]
    ds_read_b64_tr_b16 v[64:65], v1 offset:18432
    ds_read_b64_tr_b16 v[66:67], v1 offset:18688
    s_nop 0
    v_cndmask_b32 v34, 0, v45, s[66:67]
    v_cndmask_b32 v35, 0, v45, s[6:7]
    s_waitcnt lgkmcnt(8)
    v_mfma_f32_32x32x16_bf16 v[16:31], v[72:75], v[184:187], v[16:31]
    ds_read_b64_tr_b16 v[68:69], v1 offset:19456
    ds_read_b64_tr_b16 v[70:71], v1 offset:19712
    v_cmp_eq_u32 s[66:67], 4, v46
    v_cmp_eq_u32 s[6:7], 5, v46
    s_nop 0
    s_waitcnt lgkmcnt(8)
    v_mfma_f32_32x32x16_bf16 v[16:31], v[76:79], v[188:191], v[16:31]
    ds_read_b64_tr_b16 v[72:73], v1 offset:20480
    ds_read_b64_tr_b16 v[74:75], v1 offset:20736
    v_cndmask_b32 v36, 0, v45, s[66:67]
    v_cndmask_b32 v37, 0, v45, s[6:7]
    s_waitcnt lgkmcnt(8)
    v_mfma_f32_32x32x16_bf16 v[16:31], v[80:83], v[192:195], v[16:31]
    ds_read_b64_tr_b16 v[76:77], v1 offset:21504
    ds_read_b64_tr_b16 v[78:79], v1 offset:21760
    v_cmp_eq_u32 s[66:67], 6, v46
    v_cmp_eq_u32 s[6:7], 7, v46
    s_nop 0
    s_waitcnt lgkmcnt(8)
    v_mfma_f32_32x32x16_bf16 v[16:31], v[84:87], v[196:199], v[16:31]
    ds_read_b64_tr_b16 v[80:81], v1 offset:22528
    ds_read_b64_tr_b16 v[82:83], v1 offset:22784
    v_cndmask_b32 v38, 0, v45, s[66:67]
    v_cndmask_b32 v39, 0, v45, s[6:7]
    v_bfe_u32 v45, v0, 4, 1
    s_waitcnt lgkmcnt(8)
    v_mfma_f32_32x32x16_bf16 v[16:31], v[64:67], v[200:203], v[16:31]
    ds_read_b64_tr_b16 v[84:85], v1 offset:23552
    ds_read_b64_tr_b16 v[86:87], v1 offset:23808
    v_bfe_u32 v46, v0, 5, 1
    v_lshl_add_u32 v47, v45, 1, v46
    s_waitcnt lgkmcnt(8)
    v_mfma_f32_32x32x16_bf16 v[16:31], v[68:71], v[204:207], v[16:31]
    ds_read_b64_tr_b16 v[64:65], v1 offset:24576
    ds_read_b64_tr_b16 v[66:67], v1 offset:24832
    v_and_b32 v40, 15, v0
    v_mul_u32_u24 v40, 80, v40
    v_lshl_add_u32 v40, v47, 3, v40
    s_waitcnt lgkmcnt(8)
    v_mfma_f32_32x32x16_bf16 v[16:31], v[72:75], v[208:211], v[16:31]
    ds_read_b64_tr_b16 v[68:69], v1 offset:25600
    ds_read_b64_tr_b16 v[70:71], v1 offset:25856
    s_lshl_b32 s62, s4, 5
    s_add_u32 s61, s61, s62
    s_add_u32 s63, s61, 66976
    v_and_b32 v47, 1, v0
    s_waitcnt lgkmcnt(8)
    v_mfma_f32_32x32x16_bf16 v[16:31], v[76:79], v[212:215], v[16:31]
    ds_read_b64_tr_b16 v[72:73], v1 offset:26624
    ds_read_b64_tr_b16 v[74:75], v1 offset:26880
    v_lshl_add_u32 v47, v45, 1, v47
    v_lshlrev_b32 v41, 3, v47
    s_waitcnt lgkmcnt(8)
    v_mfma_f32_32x32x16_bf16 v[16:31], v[80:83], v[216:219], v[16:31]
    ds_read_b64_tr_b16 v[76:77], v1 offset:27648
    ds_read_b64_tr_b16 v[78:79], v1 offset:27904
    v_add_u32 v41, s63, v41
    s_mul_i32 s62, s4, 80
    s_sub_u32 s61, s61, s62
    s_add_u32 s61, s61, 65536
    s_waitcnt lgkmcnt(8)
    v_mfma_f32_32x32x16_bf16 v[16:31], v[84:87], v[220:223], v[16:31]
    ds_read_b64_tr_b16 v[80:81], v1 offset:28672
    ds_read_b64_tr_b16 v[82:83], v1 offset:28928
    v_add_u32 v40, s61, v40
    v_bfe_u32 v45, v0, 3, 2
    v_and_b32 v47, 3, v0
    s_waitcnt lgkmcnt(8)
    v_mfma_f32_32x32x16_bf16 v[16:31], v[64:67], v[224:227], v[16:31]
    ds_read_b64_tr_b16 v[84:85], v1 offset:29696
    ds_read_b64_tr_b16 v[86:87], v1 offset:29952
    v_lshl_add_u32 v45, v45, 2, v47
    v_mul_u32_u24 v42, 80, v45
    s_waitcnt lgkmcnt(8)
    v_mfma_f32_32x32x16_bf16 v[16:31], v[68:71], v[228:231], v[16:31]
    ds_read_b64_tr_b16 v[64:65], v1 offset:30720
    ds_read_b64_tr_b16 v[66:67], v1 offset:30976
    v_mul_u32_u24 v46, 1600, v46
    v_add_u32 v46, 65536, v46
    v_add_u32 v42, v42, v46
    s_waitcnt lgkmcnt(8)
    v_mfma_f32_32x32x16_bf16 v[16:31], v[72:75], v[232:235], v[16:31]
    ds_read_b64_tr_b16 v[68:69], v1 offset:31744
    ds_read_b64_tr_b16 v[70:71], v1 offset:32000
    v_mul_u32_u24 v43, 80, v47
    v_add_u32 v43, v43, v46
    s_waitcnt lgkmcnt(8)
    v_mfma_f32_32x32x16_bf16 v[16:31], v[76:79], v[236:239], v[16:31]
    v_add_u32 v43, 1280, v43
    v_mov_b32 v45, 68736
    s_mov_b32 s66, 0x0f0f0f0f
    s_mov_b32 s67, 0xf0f0f0f0
    s_waitcnt lgkmcnt(6)
    v_mfma_f32_32x32x16_bf16 v[16:31], v[80:83], v[240:243], v[16:31]
    v_cndmask_b32 v42, v45, v42, s[66:67]
    s_mov_b32 s66, 0x0000000f
    s_mov_b32 s67, 0x000000f0
    s_waitcnt lgkmcnt(4)
    v_mfma_f32_32x32x16_bf16 v[16:31], v[84:87], v[244:247], v[16:31]
    v_cndmask_b32 v43, v45, v43, s[66:67]
    v_and_b32 v92, 0x1f0, v4
    s_lshl_b32 s39, s36, 9
    s_add_u32 s39, s39, 655360
    s_waitcnt vmcnt(0)
    v_xor_b32 v44, s56, v160
    v_bitop3_b32 v44, v44, v161, s57 bitop3:0xf6
    v_bitop3_b32 v44, v44, v162, s58 bitop3:0xf6
    v_bitop3_b32 v44, v44, v163, s59 bitop3:0xf6
    v_and_b32 v44, 0x00010001, v44
    v_cmp_ne_u32 vcc, 0, v44
    s_nop 0
    s_cbranch_vccz B_CPGO0
    buffer_load_dwordx4 v[160:163], v95, s[28:31], s70 offen sc1
B_CP0:
    s_waitcnt lgkmcnt(2)
    v_mfma_f32_32x32x16_bf16 v[16:31], v[64:67], v[248:251], v[16:31]
    s_waitcnt lgkmcnt(0)
    v_mfma_f32_32x32x16_bf16 v[16:31], v[68:71], v[252:255], v[16:31]
    s_nop 11
    v_cvt_pk_bf16_f32 v96, v16, v17
    v_cvt_pk_bf16_f32 v97, v18, v19
    v_cvt_pk_bf16_f32 v98, v20, v21
    v_cvt_pk_bf16_f32 v99, v22, v23
    v_cvt_pk_bf16_f32 v100, v24, v25
    v_cvt_pk_bf16_f32 v101, v26, v27
    v_mfma_f32_32x32x16_bf16 v[48:63], v[8:11], v[96:99], 0
    v_cvt_pk_bf16_f32 v102, v28, v29
    v_cvt_pk_bf16_f32 v103, v30, v31
    s_nop 1
    v_mfma_f32_32x32x16_bf16 v[48:63], v[12:15], v[100:103], v[48:63]
    s_setprio 0
    s_nop 10
    v_max3_f32 v6, v48, v49, v50
    v_min3_f32 v7, v48, v49, v50
    v_max3_f32 v6, v6, v51, v52
    v_min3_f32 v7, v7, v51, v52
    v_max3_f32 v6, v6, v53, v54
    v_min3_f32 v7, v7, v53, v54
    v_max3_f32 v6, v6, v55, v56
    v_min3_f32 v7, v7, v55, v56
    v_max3_f32 v6, v6, v57, v58
    v_min3_f32 v7, v7, v57, v58
    v_max3_f32 v6, v6, v59, v60
    v_min3_f32 v7, v7, v59, v60
    v_max3_f32 v6, v6, v61, v62
    v_min3_f32 v7, v7, v61, v62
    v_max_f32 v6, v6, v63
    v_min_f32 v7, v7, v63
    v_mul_f32 v6, 0xbfb8aa3b, v6
    v_mul_f32 v7, 0x3fb8aa3b, v7
    v_fma_f32 v96, v48, s64, v6
    v_fma_f32 v97, v49, s64, v6
    v_fma_f32 v98, v50, s64, v6
    v_exp_f32 v96, v96
    v_fma_f32 v99, v51, s64, v6
    v_exp_f32 v97, v97
    v_fma_f32 v100, v52, s64, v6
    v_exp_f32 v98, v98
    v_fma_f32 v101, v53, s64, v6
    v_exp_f32 v99, v99
    v_fma_f32 v102, v54, s64, v6
    v_exp_f32 v100, v100
    v_fma_f32 v103, v55, s64, v6
    v_exp_f32 v101, v101
    v_fma_f32 v104, v56, s64, v6
    v_exp_f32 v102, v102
    v_fma_f32 v105, v57, s64, v6
    v_exp_f32 v103, v103
    v_fma_f32 v106, v58, s64, v6
    v_exp_f32 v104, v104
    v_fma_f32 v107, v59, s64, v6
    v_exp_f32 v105, v105
    v_fma_f32 v108, v60, s64, v6
    v_exp_f32 v106, v106
    v_fma_f32 v109, v61, s64, v6
    v_exp_f32 v107, v107
    v_fma_f32 v110, v62, s64, v6
    v_exp_f32 v108, v108
    v_fma_f32 v111, v63, s64, v6
    v_exp_f32 v109, v109
    v_fma_f32 v112, v48, -s64, v7
    v_exp_f32 v110, v110
    v_fma_f32 v113, v49, -s64, v7
    v_exp_f32 v111, v111
    v_fma_f32 v114, v50, -s64, v7
    v_exp_f32 v112, v112
    v_fma_f32 v115, v51, -s64, v7
    v_exp_f32 v113, v113
    v_fma_f32 v116, v52, -s64, v7
    v_exp_f32 v114, v114
    v_fma_f32 v117, v53, -s64, v7
    v_exp_f32 v115, v115
    s_cmp_lg_u32 s69, 0
    s_cbranch_scc1 B_CP1
    s_waitcnt vmcnt(0)
    v_xor_b32 v44, s56, v160
    v_bitop3_b32 v44, v44, v161, s57 bitop3:0xf6
    v_bitop3_b32 v44, v44, v162, s58 bitop3:0xf6
    v_bitop3_b32 v44, v44, v163, s59 bitop3:0xf6
    v_and_b32 v44, 0x00010001, v44
    v_cmp_ne_u32 vcc, 0, v44
    s_nop 0
    s_cbranch_vccz B_CPGO1
    buffer_load_dwordx4 v[160:163], v95, s[28:31], s70 offen sc1
B_CP1:
    v_fma_f32 v118, v54, -s64, v7
    v_exp_f32 v116, v116
    v_fma_f32 v119, v55, -s64, v7
    v_exp_f32 v117, v117
    v_fma_f32 v120, v56, -s64, v7
    v_exp_f32 v118, v118
    v_fma_f32 v121, v57, -s64, v7
    v_exp_f32 v119, v119
    v_fma_f32 v122, v58, -s64, v7
    v_exp_f32 v120, v120
    v_fma_f32 v123, v59, -s64, v7
    v_exp_f32 v121, v121
    v_fma_f32 v124, v60, -s64, v7
    v_exp_f32 v122, v122
    v_fma_f32 v125, v61, -s64, v7
    v_exp_f32 v123, v123
    v_fma_f32 v126, v62, -s64, v7
    v_exp_f32 v124, v124
    v_fma_f32 v127, v63, -s64, v7
    v_exp_f32 v125, v125
    v_exp_f32 v126, v126
    v_exp_f32 v127, v127
    v_cvt_pk_bf16_f32 v176, v96, v97
    v_cvt_pk_bf16_f32 v177, v98, v99
    v_cvt_pk_bf16_f32 v178, v100, v101
    v_cvt_pk_bf16_f32 v179, v102, v103
    v_cvt_pk_bf16_f32 v180, v104, v105
    v_cvt_pk_bf16_f32 v181, v106, v107
    v_cvt_pk_bf16_f32 v182, v108, v109
    v_cvt_pk_bf16_f32 v183, v110, v111
    v_cvt_pk_bf16_f32 v184, v112, v113
    v_cvt_pk_bf16_f32 v185, v114, v115
    v_cvt_pk_bf16_f32 v186, v116, v117
    v_cvt_pk_bf16_f32 v187, v118, v119
    v_cvt_pk_bf16_f32 v188, v120, v121
    v_cvt_pk_bf16_f32 v189, v122, v123
    v_cvt_pk_bf16_f32 v190, v124, v125
    v_cvt_pk_bf16_f32 v191, v126, v127
    s_cmp_eq_u32 s69, 0
    s_cbranch_scc1 B_H1_POLL
B_H1_CHK:
    s_setprio 2
    v_mfma_f32_16x16x32_bf16 v[48:51], v[32:35], v[160:163], 0
    s_waitcnt vmcnt(8)
    v_mfma_f32_16x16x32_bf16 v[52:55], v[32:35], v[128:131], 0
    v_xor_b32 v44, s56, v128
    v_bitop3_b32 v44, v44, v129, s57 bitop3:0xf6
    v_bitop3_b32 v44, v44, v130, s58 bitop3:0xf6
    v_bitop3_b32 v44, v44, v131, s59 bitop3:0xf6
    s_lshl_b32 s3, s44, 15
    s_add_u32 m0, s37, 49152
    s_nop 0
    buffer_load_dwordx4 v3, s[20:23], s3 offen lds
    s_waitcnt vmcnt(8)
    v_mfma_f32_16x16x32_bf16 v[52:55], v[36:39], v[132:135], v[52:55]
    v_bitop3_b32 v44, v44, v132, s56 bitop3:0xf6
    v_bitop3_b32 v44, v44, v133, s57 bitop3:0xf6
    v_bitop3_b32 v44, v44, v134, s58 bitop3:0xf6
    v_bitop3_b32 v44, v44, v135, s59 bitop3:0xf6
    s_lshl_b32 s3, s45, 15
    s_add_u32 m0, s37, 53248
    s_nop 0
    buffer_load_dwordx4 v3, s[20:23], s3 offen lds
    v_add_f32_dpp v48, v48, v48 row_ror:2 row_mask:0xf bank_mask:0xf
    v_add_f32_dpp v49, v49, v49 row_ror:2 row_mask:0xf bank_mask:0xf
    v_add_f32_dpp v50, v50, v50 row_ror:2 row_mask:0xf bank_mask:0xf
    v_add_f32_dpp v51, v51, v51 row_ror:2 row_mask:0xf bank_mask:0xf
    s_waitcnt vmcnt(8)
    v_mfma_f32_16x16x32_bf16 v[52:55], v[32:35], v[136:139], v[52:55]
    v_bitop3_b32 v44, v44, v136, s56 bitop3:0xf6
    v_bitop3_b32 v44, v44, v137, s57 bitop3:0xf6
    v_bitop3_b32 v44, v44, v138, s58 bitop3:0xf6
    v_bitop3_b32 v44, v44, v139, s59 bitop3:0xf6
    s_lshl_b32 s3, s46, 15
    s_add_u32 m0, s37, 57344
    s_nop 0
    buffer_load_dwordx4 v3, s[20:23], s3 offen lds
    v_add_f32_dpp v48, v48, v48 row_ror:4 row_mask:0xf bank_mask:0xf
    v_add_f32_dpp v49, v49, v49 row_ror:4 row_mask:0xf bank_mask:0xf
    v_add_f32_dpp v50, v50, v50 row_ror:4 row_mask:0xf bank_mask:0xf
    v_add_f32_dpp v51, v51, v51 row_ror:4 row_mask:0xf bank_mask:0xf
    s_waitcnt vmcnt(8)
    v_mfma_f32_16x16x32_bf16 v[52:55], v[36:39], v[140:143], v[52:55]
    v_bitop3_b32 v44, v44, v140, s56 bitop3:0xf6
    v_bitop3_b32 v44, v44, v141, s57 bitop3:0xf6
    v_bitop3_b32 v44, v44, v142, s58 bitop3:0xf6
    v_bitop3_b32 v44, v44, v143, s59 bitop3:0xf6
    s_lshl_b32 s3, s47, 15
    s_add_u32 m0, s37, 61440
    s_nop 0
    buffer_load_dwordx4 v3, s[20:23], s3 offen lds
    v_cvt_pk_bf16_f32 v48, v48, v49
    v_cvt_pk_bf16_f32 v49, v50, v51
    s_mov_b64 exec, 0x00030003
    ds_write_b64 v41, v[48:49]
    s_mov_b64 exec, -1
    s_waitcnt vmcnt(8)
    v_mfma_f32_16x16x32_bf16 v[52:55], v[32:35], v[144:147], v[52:55]
    v_bitop3_b32 v44, v44, v144, s56 bitop3:0xf6
    v_bitop3_b32 v44, v44, v145, s57 bitop3:0xf6
    v_bitop3_b32 v44, v44, v146, s58 bitop3:0xf6
    v_bitop3_b32 v44, v44, v147, s59 bitop3:0xf6
    s_waitcnt vmcnt(7)
    v_mfma_f32_16x16x32_bf16 v[52:55], v[36:39], v[148:151], v[52:55]
    v_bitop3_b32 v44, v44, v148, s56 bitop3:0xf6
    v_bitop3_b32 v44, v44, v149, s57 bitop3:0xf6
    v_bitop3_b32 v44, v44, v150, s58 bitop3:0xf6
    v_bitop3_b32 v44, v44, v151, s59 bitop3:0xf6
    s_waitcnt vmcnt(6)
    v_mfma_f32_16x16x32_bf16 v[52:55], v[32:35], v[152:155], v[52:55]
    v_bitop3_b32 v44, v44, v152, s56 bitop3:0xf6
    v_bitop3_b32 v44, v44, v153, s57 bitop3:0xf6
    v_bitop3_b32 v44, v44, v154, s58 bitop3:0xf6
    v_bitop3_b32 v44, v44, v155, s59 bitop3:0xf6
    s_waitcnt vmcnt(5)
    v_mfma_f32_16x16x32_bf16 v[52:55], v[36:39], v[156:159], v[52:55]
    v_bitop3_b32 v44, v44, v156, s56 bitop3:0xf6
    v_bitop3_b32 v44, v44, v157, s57 bitop3:0xf6
    v_bitop3_b32 v44, v44, v158, s58 bitop3:0xf6
    v_bitop3_b32 v44, v44, v159, s59 bitop3:0xf6
    v_and_b32 v44, 0x00010001, v44
    v_cmp_ne_u32 vcc, 0, v44
    s_nop 0
    s_cbranch_vccnz B_H1_RETRY
B_H1_OK:
    v_cvt_pk_bf16_f32 v52, v52, v53
    v_cvt_pk_bf16_f32 v53, v54, v55
    ds_write_b64 v40, v[52:53]
    s_waitcnt vmcnt(4)
    v_xor_b32 v164, s60, v164
    v_xor_b32 v165, s77, v165
    v_or_b32 v164, v164, v165
    v_cmp_ne_u32 vcc, 0, v164
    s_nop 0
    s_or_b32 s69, vcc_lo, vcc_hi
    s_waitcnt lgkmcnt(0)
    s_barrier
    ds_read_b128 v[128:131], v43 offset:0
    ds_read_b128 v[132:135], v43 offset:16
    ds_read_b128 v[136:139], v43 offset:32
    ds_read_b128 v[140:143], v43 offset:48
    ds_read_b128 v[144:147], v42 offset:0
    ds_read_b128 v[148:151], v42 offset:16
    ds_read_b128 v[152:155], v42 offset:32
    ds_read_b128 v[156:159], v42 offset:48
    s_lshl_b32 s3, s40, 15
    s_add_u32 s3, s3, 0x40000
    s_add_u32 m0, s37, 0
    s_nop 0
    buffer_load_dwordx4 v3, s[20:23], s3 offen lds
    s_lshl2_add_u32 s61, s74, s34
    s_lshl_b32 s71, s61, 7
    s_add_u32 s71, s71, 786432
    s_lshl_b32 s61, s61, 15
    s_add_u32 s70, s61, 1024
    v_and_b32 v64, 0x70, v4
    v_mov_b32 v65, 0
    v_mov_b32 v70, s60
    s_waitcnt lgkmcnt(7)
    v_mfma_f32_32x32x16_bf16 v[48:63], v[128:131], v[176:179], 0
    s_lshl_b32 s3, s41, 15
    s_add_u32 s3, s3, 0x40000
    s_add_u32 m0, s37, 4096
    s_nop 0
    buffer_load_dwordx4 v3, s[20:23], s3 offen lds
    s_waitcnt lgkmcnt(6)
    v_mfma_f32_32x32x16_bf16 v[48:63], v[132:135], v[180:183], v[48:63]
    s_lshl_b32 s3, s42, 15
    s_add_u32 s3, s3, 0x40000
    s_add_u32 m0, s37, 8192
    s_nop 0
    buffer_load_dwordx4 v3, s[20:23], s3 offen lds
    s_waitcnt lgkmcnt(5)
    v_mfma_f32_32x32x16_bf16 v[48:63], v[136:139], v[184:187], v[48:63]
    s_lshl_b32 s3, s43, 15
    s_add_u32 s3, s3, 0x40000
    s_add_u32 m0, s37, 12288
    s_nop 0
    buffer_load_dwordx4 v3, s[20:23], s3 offen lds
    s_waitcnt lgkmcnt(4)
    v_mfma_f32_32x32x16_bf16 v[48:63], v[140:143], v[188:191], v[48:63]
    s_lshl_b32 s3, s44, 15
    s_add_u32 s3, s3, 0x40000
    s_add_u32 m0, s37, 16384
    s_nop 0
    buffer_load_dwordx4 v3, s[20:23], s3 offen lds
    s_waitcnt lgkmcnt(3)
    v_mfma_f32_32x32x16_bf16 v[16:31], v[144:147], v[176:179], 0
    s_lshl_b32 s3, s45, 15
    s_add_u32 s3, s3, 0x40000
    s_add_u32 m0, s37, 20480
    s_nop 0
    buffer_load_dwordx4 v3, s[20:23], s3 offen lds
    s_waitcnt lgkmcnt(2)
    v_mfma_f32_32x32x16_bf16 v[16:31], v[148:151], v[180:183], v[16:31]
    s_lshl_b32 s3, s46, 15
    s_add_u32 s3, s3, 0x40000
    s_add_u32 m0, s37, 24576
    s_nop 0
    buffer_load_dwordx4 v3, s[20:23], s3 offen lds
    s_waitcnt lgkmcnt(1)
    v_mfma_f32_32x32x16_bf16 v[32:47], v[152:155], v[184:187], 0
    s_lshl_b32 s3, s47, 15
    s_add_u32 s3, s3, 0x40000
    s_add_u32 m0, s37, 28672
    s_nop 0
    buffer_load_dwordx4 v3, s[20:23], s3 offen lds
    s_waitcnt lgkmcnt(0)
    v_mfma_f32_32x32x16_bf16 v[32:47], v[156:159], v[188:191], v[32:47]
    v_rcp_f32 v96, v48
    v_rcp_f32 v97, v49
    v_mul_f32 v98, v50, v96
    v_fma_f32 v98, v51, v97, v98
    v_add_f32 v98, 0x358637bd, v98
    v_rcp_f32 v98, v98
    s_nop 0
    v_mul_f32 v96, v96, v98
    v_mul_f32 v97, v97, v98
    v_mul_f32 v16, v16, v96
    v_mul_f32 v17, v17, v96
    v_mul_f32 v18, v18, v96
    v_mul_f32 v19, v19, v96
    v_mul_f32 v20, v20, v96
    v_mul_f32 v21, v21, v96
    v_mul_f32 v22, v22, v96
    v_mul_f32 v23, v23, v96
    v_fmac_f32 v16, v32, v97
    v_fmac_f32 v17, v33, v97
    v_fmac_f32 v18, v34, v97
    v_fmac_f32 v19, v35, v97
    v_fmac_f32 v20, v36, v97
    v_fmac_f32 v21, v37, v97
    v_fmac_f32 v22, v38, v97
    v_fmac_f32 v23, v39, v97
    v_cvt_pk_bf16_f32 v112, v16, v17
    v_cvt_pk_bf16_f32 v113, v18, v19
    v_cvt_pk_bf16_f32 v114, v20, v21
    v_cvt_pk_bf16_f32 v115, v22, v23
    s_cmp_eq_u32 s69, 0
    s_cbranch_scc1 B_TMa0
    buffer_store_dwordx4 v[112:115], v4, s[24:27], s65 offen offset:0 sc1
    s_branch B_TMb0
B_TMa0:
    buffer_store_dwordx4 v[112:115], v4, s[24:27], s65 offen offset:0
B_TMb0:
    v_mul_f32 v24, v24, v96
    v_mul_f32 v25, v25, v96
    v_mul_f32 v26, v26, v96
    v_mul_f32 v27, v27, v96
    v_mul_f32 v28, v28, v96
    v_mul_f32 v29, v29, v96
    v_mul_f32 v30, v30, v96
    v_mul_f32 v31, v31, v96
    v_fmac_f32 v24, v40, v97
    v_fmac_f32 v25, v41, v97
    v_fmac_f32 v26, v42, v97
    v_fmac_f32 v27, v43, v97
    v_fmac_f32 v28, v44, v97
    v_fmac_f32 v29, v45, v97
    v_fmac_f32 v30, v46, v97
    v_fmac_f32 v31, v47, v97
    v_cvt_pk_bf16_f32 v116, v24, v25
    v_cvt_pk_bf16_f32 v117, v26, v27
    v_cvt_pk_bf16_f32 v118, v28, v29
    v_cvt_pk_bf16_f32 v119, v30, v31
    s_cmp_eq_u32 s69, 0
    s_cbranch_scc1 B_TMa1
    buffer_store_dwordx4 v[116:119], v4, s[24:27], s65 offen offset:2048 sc1
    s_branch B_TMb1
B_TMa1:
    buffer_store_dwordx4 v[116:119], v4, s[24:27], s65 offen offset:2048
B_TMb1:
    v_bfe_u32 v100, v0, 2, 2
    v_bfe_u32 v101, v0, 5, 1
    v_lshl_add_u32 v105, v101, 4, v100
    v_lshlrev_b32 v96, 7, v105
    v_lshrrev_b32 v100, 1, v100
    v_xor_b32 v100, s4, v100
    v_lshl_add_u32 v96, v100, 6, v96
    v_and_b32 v100, 63, v2
    v_add_u32 v96, v96, v100
    s_xor_b32 s63, s4, 1
    s_lshl_b32 s63, s63, 15
    v_add_u32 v96, s63, v96
    v_xor_b32 v97, 64, v96
    v_and_b32 v100, 31, v0
    v_lshlrev_b32 v101, 5, v101
    v_lshl_add_u32 v99, v100, 11, v101
    s_lshl1_add_u32 s61, s74, s5
    s_lshl_b32 s61, s61, 16
    s_lshl1_add_u32 s63, s75, s4
    s_lshl_b32 s63, s63, 6
    s_add_u32 s76, s61, s63
    s_add_u32 s76, s76, 1024
    s_add_u32 s61, s38, 65536
    s_xor_b32 s63, s38, 4096
    s_add_u32 s63, s63, 65536
    v_add_u32 v102, s61, v4
    v_add_u32 v103, s63, v4
    v_and_b32 v100, 31, v0
    v_bfe_u32 v101, v0, 5, 1
    s_lshl_b32 s61, s4, 2
    v_lshl_add_u32 v101, v101, 1, s61
    v_and_b32 v105, 7, v0
    v_xor_b32 v101, v101, v105
    v_lshlrev_b32 v101, 4, v101
    v_lshl_add_u32 v101, v100, 7, v101
    s_lshl_b32 s61, s5, 12
    v_add_u32 v106, s61, v101
    v_xor_b32 v107, 16, v106
    v_lshlrev_b32 v108, 4, v0
    v_bfe_u32 v100, v0, 3, 3
    v_xor_b32 v100, v100, v105
    v_lshlrev_b32 v100, 4, v100
    v_lshrrev_b32 v101, 3, v0
    v_lshl_add_u32 v99, v101, 11, v100
    s_lshl_b32 s61, s74, 17
    s_lshl_b32 s63, s75, 7
    s_add_u32 s76, s61, s63
    s_add_u32 s76, s76, 1024
    s_add_u32 s62, s76, 65536
    s_waitcnt vmcnt(0)
    s_mov_b64 exec, 1
    s_cmp_eq_u32 s69, 0
    s_cbranch_scc1 B_TMa2
    buffer_store_dword v70, v65, s[28:31], s16 offen sc1
    s_branch B_TMb2
B_TMa2:
    buffer_store_dword v70, v65, s[28:31], s16 offen
B_TMb2:
    s_mov_b64 exec, -1
    s_lshl_b32 s40, s40, 12
    s_add_u32 s40, s40, s70
    s_lshl_b32 s41, s41, 12
    s_add_u32 s41, s41, s70
    s_lshl_b32 s42, s42, 12
    s_add_u32 s42, s42, s70
    s_lshl_b32 s43, s43, 12
    s_add_u32 s43, s43, s70
    s_lshl_b32 s44, s44, 12
    s_add_u32 s44, s44, s70
    s_lshl_b32 s45, s45, 12
    s_add_u32 s45, s45, s70
    s_lshl_b32 s46, s46, 12
    s_add_u32 s46, s46, s70
    s_lshl_b32 s47, s47, 12
    s_add_u32 s47, s47, s70
    s_lshl_b32 s73, s74, 9
    s_add_u32 s73, s73, 819200
    s_lshl2_add_u32 s72, s75, s34
    s_lshl_b32 s72, s72, 4
    s_add_u32 s72, s72, s73
    v_and_b32 v71, 0x1f0, v4
B_H2_POLL:
    buffer_load_dword v66, v64, s[28:31], s71 offen sc1
    s_add_u32 s68, s68, 1
    s_cmp_gt_u32 s68, 200000
    s_cbranch_scc1 B_H2_FIRST
    s_waitcnt vmcnt(0)
    v_cmp_ne_u32 vcc, s60, v66
    s_nop 0
    s_cbranch_vccnz B_H2_POLL
B_H2_FIRST:
    buffer_load_dwordx4 v[128:131], v4, s[24:27], s40 offen offset:0 sc1
    buffer_load_dwordx4 v[132:135], v4, s[24:27], s40 offen offset:2048 sc1
    buffer_load_dwordx4 v[136:139], v4, s[24:27], s41 offen offset:0 sc1
    buffer_load_dwordx4 v[140:143], v4, s[24:27], s41 offen offset:2048 sc1
    buffer_load_dwordx4 v[144:147], v4, s[24:27], s42 offen offset:0 sc1
    buffer_load_dwordx4 v[148:151], v4, s[24:27], s42 offen offset:2048 sc1
    buffer_load_dwordx4 v[152:155], v4, s[24:27], s43 offen offset:0 sc1
    buffer_load_dwordx4 v[156:159], v4, s[24:27], s43 offen offset:2048 sc1
    s_waitcnt vmcnt(8)
    s_barrier
B_H2_GO:
    ds_read_b64_tr_b16 v[196:197], v97 offset:0
    ds_read_b64_tr_b16 v[198:199], v97 offset:512
    ds_read_b64_tr_b16 v[192:193], v96 offset:0
    ds_read_b64_tr_b16 v[194:195], v96 offset:512
    ds_read_b64_tr_b16 v[204:205], v97 offset:1024
    ds_read_b64_tr_b16 v[206:207], v97 offset:1536
    ds_read_b64_tr_b16 v[200:201], v96 offset:1024
    ds_read_b64_tr_b16 v[202:203], v96 offset:1536
    ds_read_b64_tr_b16 v[212:213], v97 offset:4096
    ds_read_b64_tr_b16 v[214:215], v97 offset:4608
    ds_read_b64_tr_b16 v[208:209], v96 offset:4096
    ds_read_b64_tr_b16 v[210:211], v96 offset:4608
    s_waitcnt vmcnt(7) lgkmcnt(10)
    v_mfma_f32_32x32x16_bf16 v[48:63], v[196:199], v[128:131], 0
    buffer_load_dwordx4 v[160:163], v4, s[24:27], s44 offen offset:0 sc1
    ds_read_b64_tr_b16 v[220:221], v97 offset:5120
    ds_read_b64_tr_b16 v[222:223], v97 offset:5632
    s_waitcnt lgkmcnt(10)
    v_mfma_f32_32x32x16_bf16 v[16:31], v[192:195], v[128:131], 0
    ds_read_b64_tr_b16 v[216:217], v96 offset:5120
    ds_read_b64_tr_b16 v[218:219], v96 offset:5632
    s_waitcnt vmcnt(7) lgkmcnt(10)
    v_mfma_f32_32x32x16_bf16 v[48:63], v[204:207], v[132:135], v[48:63]
    buffer_load_dwordx4 v[164:167], v4, s[24:27], s44 offen offset:2048 sc1
    ds_read_b64_tr_b16 v[228:229], v97 offset:8192
    ds_read_b64_tr_b16 v[230:231], v97 offset:8704
    s_waitcnt lgkmcnt(10)
    v_mfma_f32_32x32x16_bf16 v[16:31], v[200:203], v[132:135], v[16:31]
    ds_read_b64_tr_b16 v[224:225], v96 offset:8192
    ds_read_b64_tr_b16 v[226:227], v96 offset:8704
    s_waitcnt vmcnt(7) lgkmcnt(10)
    v_mfma_f32_32x32x16_bf16 v[48:63], v[212:215], v[136:139], v[48:63]
    buffer_load_dwordx4 v[168:171], v4, s[24:27], s45 offen offset:0 sc1
    ds_read_b64_tr_b16 v[196:197], v97 offset:9216
    ds_read_b64_tr_b16 v[198:199], v97 offset:9728
    s_waitcnt lgkmcnt(10)
    v_mfma_f32_32x32x16_bf16 v[16:31], v[208:211], v[136:139], v[16:31]
    ds_read_b64_tr_b16 v[192:193], v96 offset:9216
    ds_read_b64_tr_b16 v[194:195], v96 offset:9728
    s_waitcnt vmcnt(7) lgkmcnt(10)
    v_mfma_f32_32x32x16_bf16 v[48:63], v[220:223], v[140:143], v[48:63]
    buffer_load_dwordx4 v[172:175], v4, s[24:27], s45 offen offset:2048 sc1
    ds_read_b64_tr_b16 v[204:205], v97 offset:12288
    ds_read_b64_tr_b16 v[206:207], v97 offset:12800
    s_waitcnt lgkmcnt(10)
    v_mfma_f32_32x32x16_bf16 v[16:31], v[216:219], v[140:143], v[16:31]
    ds_read_b64_tr_b16 v[200:201], v96 offset:12288
    ds_read_b64_tr_b16 v[202:203], v96 offset:12800
    s_waitcnt vmcnt(7) lgkmcnt(10)
    v_mfma_f32_32x32x16_bf16 v[48:63], v[228:231], v[144:147], v[48:63]
    buffer_load_dwordx4 v[176:179], v4, s[24:27], s46 offen offset:0 sc1
    ds_read_b64_tr_b16 v[212:213], v97 offset:13312
    ds_read_b64_tr_b16 v[214:215], v97 offset:13824
    s_waitcnt lgkmcnt(10)
    v_mfma_f32_32x32x16_bf16 v[16:31], v[224:227], v[144:147], v[16:31]
    ds_read_b64_tr_b16 v[208:209], v96 offset:13312
    ds_read_b64_tr_b16 v[210:211], v96 offset:13824
    s_waitcnt vmcnt(7) lgkmcnt(10)
    v_mfma_f32_32x32x16_bf16 v[48:63], v[196:199], v[148:151], v[48:63]
    buffer_load_dwordx4 v[180:183], v4, s[24:27], s46 offen offset:2048 sc1
    ds_read_b64_tr_b16 v[220:221], v97 offset:16384
    ds_read_b64_tr_b16 v[222:223], v97 offset:16896
    s_waitcnt lgkmcnt(10)
    v_mfma_f32_32x32x16_bf16 v[16:31], v[192:195], v[148:151], v[16:31]
    ds_read_b64_tr_b16 v[216:217], v96 offset:16384
    ds_read_b64_tr_b16 v[218:219], v96 offset:16896
    s_waitcnt vmcnt(7) lgkmcnt(10)
    v_mfma_f32_32x32x16_bf16 v[48:63], v[204:207], v[152:155], v[48:63]
    buffer_load_dwordx4 v[184:187], v4, s[24:27], s47 offen offset:0 sc1
    ds_read_b64_tr_b16 v[228:229], v97 offset:17408
    ds_read_b64_tr_b16 v[230:231], v97 offset:17920
    s_waitcnt lgkmcnt(10)
    v_mfma_f32_32x32x16_bf16 v[16:31], v[200:203], v[152:155], v[16:31]
    ds_read_b64_tr_b16 v[224:225], v96 offset:17408
    ds_read_b64_tr_b16 v[226:227], v96 offset:17920
    s_waitcnt vmcnt(7) lgkmcnt(10)
    v_mfma_f32_32x32x16_bf16 v[48:63], v[212:215], v[156:159], v[48:63]
    buffer_load_dwordx4 v[188:191], v4, s[24:27], s47 offen offset:2048 sc1
    ds_read_b64_tr_b16 v[196:197], v97 offset:20480
    ds_read_b64_tr_b16 v[198:199], v97 offset:20992
    s_waitcnt lgkmcnt(10)
    v_mfma_f32_32x32x16_bf16 v[16:31], v[208:211], v[156:159], v[16:31]
    ds_read_b64_tr_b16 v[192:193], v96 offset:20480
    ds_read_b64_tr_b16 v[194:195], v96 offset:20992
    s_waitcnt vmcnt(7) lgkmcnt(10)
    v_mfma_f32_32x32x16_bf16 v[48:63], v[220:223], v[160:163], v[48:63]
    ds_read_b64_tr_b16 v[204:205], v97 offset:21504
    ds_read_b64_tr_b16 v[206:207], v97 offset:22016
    s_waitcnt lgkmcnt(10)
    v_mfma_f32_32x32x16_bf16 v[16:31], v[216:219], v[160:163], v[16:31]
    ds_read_b64_tr_b16 v[200:201], v96 offset:21504
    ds_read_b64_tr_b16 v[202:203], v96 offset:22016
    s_waitcnt vmcnt(6) lgkmcnt(10)
    v_mfma_f32_32x32x16_bf16 v[48:63], v[228:231], v[164:167], v[48:63]
    ds_read_b64_tr_b16 v[212:213], v97 offset:24576
    ds_read_b64_tr_b16 v[214:215], v97 offset:25088
    s_waitcnt lgkmcnt(10)
    v_mfma_f32_32x32x16_bf16 v[16:31], v[224:227], v[164:167], v[16:31]
    ds_read_b64_tr_b16 v[208:209], v96 offset:24576
    ds_read_b64_tr_b16 v[210:211], v96 offset:25088
    s_waitcnt vmcnt(5) lgkmcnt(10)
    v_mfma_f32_32x32x16_bf16 v[48:63], v[196:199], v[168:171], v[48:63]
    ds_read_b64_tr_b16 v[220:221], v97 offset:25600
    ds_read_b64_tr_b16 v[222:223], v97 offset:26112
    s_waitcnt lgkmcnt(10)
    v_mfma_f32_32x32x16_bf16 v[16:31], v[192:195], v[168:171], v[16:31]
    ds_read_b64_tr_b16 v[216:217], v96 offset:25600
    ds_read_b64_tr_b16 v[218:219], v96 offset:26112
    s_waitcnt vmcnt(4) lgkmcnt(10)
    v_mfma_f32_32x32x16_bf16 v[48:63], v[204:207], v[172:175], v[48:63]
    ds_read_b64_tr_b16 v[228:229], v97 offset:28672
    ds_read_b64_tr_b16 v[230:231], v97 offset:29184
    s_waitcnt lgkmcnt(10)
    v_mfma_f32_32x32x16_bf16 v[16:31], v[200:203], v[172:175], v[16:31]
    ds_read_b64_tr_b16 v[224:225], v96 offset:28672
    ds_read_b64_tr_b16 v[226:227], v96 offset:29184
    s_waitcnt vmcnt(3) lgkmcnt(10)
    v_mfma_f32_32x32x16_bf16 v[48:63], v[212:215], v[176:179], v[48:63]
    ds_read_b64_tr_b16 v[196:197], v97 offset:29696
    ds_read_b64_tr_b16 v[198:199], v97 offset:30208
    s_waitcnt lgkmcnt(10)
    v_mfma_f32_32x32x16_bf16 v[16:31], v[208:211], v[176:179], v[16:31]
    ds_read_b64_tr_b16 v[192:193], v96 offset:29696
    ds_read_b64_tr_b16 v[194:195], v96 offset:30208
    s_waitcnt vmcnt(2) lgkmcnt(10)
    v_mfma_f32_32x32x16_bf16 v[48:63], v[220:223], v[180:183], v[48:63]
    s_waitcnt lgkmcnt(8)
    v_mfma_f32_32x32x16_bf16 v[16:31], v[216:219], v[180:183], v[16:31]
    s_waitcnt vmcnt(1) lgkmcnt(6)
    v_mfma_f32_32x32x16_bf16 v[48:63], v[228:231], v[184:187], v[48:63]
    s_waitcnt lgkmcnt(4)
    v_mfma_f32_32x32x16_bf16 v[16:31], v[224:227], v[184:187], v[16:31]
    s_waitcnt vmcnt(0) lgkmcnt(2)
    v_mfma_f32_32x32x16_bf16 v[48:63], v[196:199], v[188:191], v[48:63]
    s_mov_b64 exec, 1
    s_cmp_eq_u32 s69, 0
    s_cbranch_scc1 B_TMa3
    buffer_store_dword v70, v65, s[28:31], s72 offen sc1
    s_branch B_TMb3
B_TMa3:
    buffer_store_dword v70, v65, s[28:31], s72 offen
B_TMb3:
    s_mov_b64 exec, -1
    s_waitcnt lgkmcnt(0)
    v_mfma_f32_32x32x16_bf16 v[16:31], v[192:195], v[188:191], v[16:31]
B_H2_OK:
    s_nop 2
    ds_write_b128 v102, v[48:51] offset:0
    ds_write_b128 v102, v[52:55] offset:1024
    ds_write_b128 v102, v[56:59] offset:2048
    ds_write_b128 v102, v[60:63] offset:3072
    s_waitcnt lgkmcnt(0)
    s_barrier
    ds_read_b128 v[48:51], v103 offset:0
    ds_read_b128 v[52:55], v103 offset:1024
    ds_read_b128 v[56:59], v103 offset:2048
    ds_read_b128 v[60:63], v103 offset:3072
    buffer_load_dword v66, v71, s[28:31], s73 offen sc1
    s_waitcnt lgkmcnt(3)
    v_add_f32 v16, v16, v48
    v_add_f32 v17, v17, v49
    v_add_f32 v18, v18, v50
    v_add_f32 v19, v19, v51
    s_waitcnt lgkmcnt(2)
    v_add_f32 v20, v20, v52
    v_add_f32 v21, v21, v53
    v_add_f32 v22, v22, v54
    v_add_f32 v23, v23, v55
    v_cvt_pk_bf16_f32 v112, v16, v17
    v_cvt_pk_bf16_f32 v113, v18, v19
    v_cvt_pk_bf16_f32 v114, v20, v21
    v_cvt_pk_bf16_f32 v115, v22, v23
    ds_write_b128 v106, v[112:115]
    s_waitcnt lgkmcnt(2)
    v_add_f32 v24, v24, v56
    v_add_f32 v25, v25, v57
    v_add_f32 v26, v26, v58
    v_add_f32 v27, v27, v59
    s_waitcnt lgkmcnt(1)
    v_add_f32 v28, v28, v60
    v_add_f32 v29, v29, v61
    v_add_f32 v30, v30, v62
    v_add_f32 v31, v31, v63
    v_cvt_pk_bf16_f32 v116, v24, v25
    v_cvt_pk_bf16_f32 v117, v26, v27
    v_cvt_pk_bf16_f32 v118, v28, v29
    v_cvt_pk_bf16_f32 v119, v30, v31
    ds_write_b128 v107, v[116:119]
    s_waitcnt lgkmcnt(0)
    s_barrier
    ds_read_b128 v[48:51], v108
    ds_read_b128 v[52:55], v108 offset:4096
B_DN_CHK:
    s_waitcnt vmcnt(0)
    v_cmp_ne_u32 vcc, s60, v66
    s_nop 0
    s_cbranch_vccnz B_DN_AGAIN
B_DN_OK:
    s_waitcnt lgkmcnt(1)
    buffer_store_dwordx4 v[48:51], v99, s[24:27], s76 offen nt
    s_waitcnt lgkmcnt(0)
    buffer_store_dwordx4 v[52:55], v99, s[24:27], s62 offen nt
    s_or_b32 s61, s2, s34
    s_cmp_lg_u32 s61, 0
    s_cbranch_scc1 B_END
    v_mov_b32 v96, s60
    v_mov_b32 v97, 0
    s_mov_b64 exec, 1
    buffer_store_dword v96, v97, s[28:31], 0 offen offset:0 sc1
B_END:
    s_endpgm
B_CPGO0:
    buffer_load_dwordx4 v[128:131], v94, s[28:31], s70 offen offset:0 sc1
    buffer_load_dwordx4 v[132:135], v94, s[28:31], s70 offen offset:256 sc1
    buffer_load_dwordx4 v[136:139], v94, s[28:31], s71 offen offset:0 sc1
    buffer_load_dwordx4 v[140:143], v94, s[28:31], s71 offen offset:256 sc1
    buffer_load_dwordx4 v[144:147], v94, s[28:31], s72 offen offset:0 sc1
    buffer_load_dwordx4 v[148:151], v94, s[28:31], s72 offen offset:256 sc1
    buffer_load_dwordx4 v[152:155], v94, s[28:31], s73 offen offset:0 sc1
    buffer_load_dwordx4 v[156:159], v94, s[28:31], s73 offen offset:256 sc1
    buffer_load_dwordx2 v[164:165], v92, s[28:31], s39 offen sc1
    s_mov_b32 s69, 1
    s_branch B_CP0
B_CPGO1:
    buffer_load_dwordx4 v[128:131], v94, s[28:31], s70 offen offset:0 sc1
    buffer_load_dwordx4 v[132:135], v94, s[28:31], s70 offen offset:256 sc1
    buffer_load_dwordx4 v[136:139], v94, s[28:31], s71 offen offset:0 sc1
    buffer_load_dwordx4 v[140:143], v94, s[28:31], s71 offen offset:256 sc1
    buffer_load_dwordx4 v[144:147], v94, s[28:31], s72 offen offset:0 sc1
    buffer_load_dwordx4 v[148:151], v94, s[28:31], s72 offen offset:256 sc1
    buffer_load_dwordx4 v[152:155], v94, s[28:31], s73 offen offset:0 sc1
    buffer_load_dwordx4 v[156:159], v94, s[28:31], s73 offen offset:256 sc1
    buffer_load_dwordx2 v[164:165], v92, s[28:31], s39 offen sc1
    s_mov_b32 s69, 1
    s_branch B_CP1
B_H1_POLL:
    s_waitcnt vmcnt(0)
    v_xor_b32 v44, s56, v160
    v_bitop3_b32 v44, v44, v161, s57 bitop3:0xf6
    v_bitop3_b32 v44, v44, v162, s58 bitop3:0xf6
    v_bitop3_b32 v44, v44, v163, s59 bitop3:0xf6
    v_and_b32 v44, 0x00010001, v44
    v_cmp_ne_u32 vcc, 0, v44
    s_add_u32 s68, s68, 1
    s_cmp_gt_u32 s68, 200000
    s_cbranch_scc1 B_H1_GO
    s_cbranch_vccz B_H1_GO
    buffer_load_dwordx4 v[160:163], v95, s[28:31], s70 offen sc1
    s_branch B_H1_POLL
B_H1_GO:
    buffer_load_dwordx4 v[128:131], v94, s[28:31], s70 offen offset:0 sc1
    buffer_load_dwordx4 v[132:135], v94, s[28:31], s70 offen offset:256 sc1
    buffer_load_dwordx4 v[136:139], v94, s[28:31], s71 offen offset:0 sc1
    buffer_load_dwordx4 v[140:143], v94, s[28:31], s71 offen offset:256 sc1
    buffer_load_dwordx4 v[144:147], v94, s[28:31], s72 offen offset:0 sc1
    buffer_load_dwordx4 v[148:151], v94, s[28:31], s72 offen offset:256 sc1
    buffer_load_dwordx4 v[152:155], v94, s[28:31], s73 offen offset:0 sc1
    buffer_load_dwordx4 v[156:159], v94, s[28:31], s73 offen offset:256 sc1
    buffer_load_dwordx2 v[164:165], v92, s[28:31], s39 offen sc1
    s_mov_b32 s69, 1
    s_branch B_H1_CHK
B_H1_RETRY:
    s_add_u32 s68, s68, 1
    s_cmp_gt_u32 s68, 200000
    s_cbranch_scc1 B_H1_OK
    s_sleep 2
    buffer_load_dwordx4 v[128:131], v94, s[28:31], s70 offen offset:0 sc1
    buffer_load_dwordx4 v[132:135], v94, s[28:31], s70 offen offset:256 sc1
    buffer_load_dwordx4 v[136:139], v94, s[28:31], s71 offen offset:0 sc1
    buffer_load_dwordx4 v[140:143], v94, s[28:31], s71 offen offset:256 sc1
    buffer_load_dwordx4 v[144:147], v94, s[28:31], s72 offen offset:0 sc1
    buffer_load_dwordx4 v[148:151], v94, s[28:31], s72 offen offset:256 sc1
    buffer_load_dwordx4 v[152:155], v94, s[28:31], s73 offen offset:0 sc1
    buffer_load_dwordx4 v[156:159], v94, s[28:31], s73 offen offset:256 sc1
    s_waitcnt vmcnt(0)
    s_branch B_H1_CHK
B_DN_AGAIN:
    s_add_u32 s68, s68, 1
    s_cmp_gt_u32 s68, 200000
    s_cbranch_scc1 B_DN_OK
    buffer_load_dword v66, v71, s[28:31], s73 offen sc1
    s_waitcnt vmcnt(0)
    s_branch B_DN_CHK
A_REST:
    s_getreg_b32 s69, hwreg(HW_REG_XCC_ID, 0, 4)
    s_cmp_lg_u32 s46, 3
    s_cbranch_scc1 A_NOTOUCH
    s_lshl_b32 s49, s44, 5
    s_add_u32 s49, s49, s45
    s_lshl_b32 s50, s49, 2
    v_and_b32 v122, 3, v0
    v_add_u32 v122, s50, v122
    v_mul_u32_u24 v123, 640, v122
    v_add_u32 v125, 9437696, v123
    v_lshlrev_b32 v123, 11, v122
    v_add_u32 v123, 10487680, v123
    s_mov_b64 s[60:61], 0xf0
    v_cndmask_b32 v125, v125, v123, s[60:61]
    v_lshlrev_b32 v123, 4, v122
    v_add_u32 v123, 393216, v123
    s_mov_b64 s[60:61], 0xf00
    v_cndmask_b32 v125, v125, v123, s[60:61]
    s_lshl_b32 s49, s49, 4
    s_add_u32 s49, s49, 4096
    v_mov_b32 v123, s49
    s_mov_b64 s[60:61], 0xf000
    v_cndmask_b32 v125, v125, v123, s[60:61]
    s_and_b32 s49, s45, 3
    s_lshl2_add_u32 s49, s44, s49
    s_lshl_b32 s49, s49, 7
    s_add_u32 s49, s49, 655360
    v_mov_b32 v123, s49
    s_mov_b64 s[60:61], 0x2000
    v_cndmask_b32 v125, v125, v123, s[60:61]
    s_and_b32 s49, s45, 15
    s_lshl4_add_u32 s49, s44, s49
    s_lshl_b32 s49, s49, 7
    s_lshr_b32 s50, s45, 4
    s_mul_i32 s50, s50, 32768
    s_add_u32 s49, s49, s50
    s_add_u32 s49, s49, 786432
    v_mov_b32 v123, s49
    s_mov_b64 s[60:61], 0x4000
    v_cndmask_b32 v125, v125, v123, s[60:61]
    s_mov_b64 exec, 0x7f0f
    buffer_load_dword v126, v125, s[40:43], 0 offen
    s_mov_b64 exec, -1
A_NOTOUCH:
    s_cmp_lg_u32 s46, 2
    s_cbranch_scc1 A_NOMP
    s_load_dwordx2 s[72:73], s[0:1], 96
    s_load_dwordx2 s[76:77], s[0:1], 80
    s_lshl_b32 s49, s44, 5
    s_add_u32 s49, s49, s45
    s_lshl_b32 s50, s49, 11
    s_mul_i32 s49, s49, 6144
    v_lshlrev_b32 v117, 7, v2
    v_bfe_u32 v118, v0, 3, 1
    v_mul_u32_u24 v118, 3072, v118
    v_and_b32 v119, 7, v0
    v_lshl_add_u32 v118, v119, 7, v118
    v_bfe_u32 v119, v0, 4, 1
    v_xor_b32 v119, 1, v119
    v_lshl_add_u32 v118, v119, 11, v118
    s_mov_b32 s74, 0x80000
    s_mov_b32 s75, 0x20000
    s_waitcnt lgkmcnt(0)
    s_mov_b64 exec, 0xffff
    buffer_load_dword v120, v117, s[72:75], s50 offen
    s_mov_b32 s72, s76
    s_mov_b32 s73, s77
    s_mov_b32 s74, 0x180000
    s_mov_b64 exec, 0xffff
    buffer_load_dword v121, v118, s[72:75], s49 offen
    s_mov_b64 exec, -1
A_NOMP:
    v_bfe_u32 v3, v0, 2, 2
    v_bfe_u32 v4, v0, 5, 1
    v_lshrrev_b32 v5, 1, v3
    v_xor_b32 v4, v4, v5
    v_lshlrev_b32 v3, 7, v3
    v_lshl_add_u32 v3, v4, 6, v3
    v_bfe_u32 v4, v0, 4, 1
    v_lshl_add_u32 v3, v4, 5, v3
    v_and_b32 v4, 3, v0
    v_lshl_add_u32 v3, v4, 3, v3
    s_lshl_b32 s49, s46, 11
    s_add_u32 s49, s49, 62016
    v_add_u32 v21, s49, v3
    s_lshl_b32 s49, s46, 1
    v_and_b32 v3, 7, v0
    v_xor_b32 v3, s49, v3
    v_lshlrev_b32 v3, 4, v3
    v_lshl_add_u32 v3, v2, 7, v3
    v_add_u32 v22, 70208, v3
    v_xor_b32 v3, 16, v3
    v_add_u32 v23, 70208, v3
    v_lshlrev_b32 v24, 4, v0
    v_add_u32 v24, 62016, v24
    v_lshlrev_b32 v27, 4, v2
    v_bfe_u32 v3, v0, 3, 3
    v_and_b32 v4, 7, v0
    v_xor_b32 v3, v3, v4
    v_lshlrev_b32 v3, 4, v3
    v_lshrrev_b32 v4, 3, v0
    v_lshl_add_u32 v25, v4, 11, v3
    s_lshl_b32 s49, s45, 17
    s_lshl_b32 s50, s44, 7
    s_add_u32 s71, s49, s50
    s_add_u32 s72, s71, 65536
    s_mul_i32 s66, s47, 3328
    s_add_u32 s66, s66, 62016
    s_mul_i32 s67, s47, 4640
    s_add_u32 s67, s67, 70208
    s_waitcnt lgkmcnt(0)
    s_waitcnt vmcnt(8)
    v_readfirstlane_b32 s58, v1
    s_nop 0
    s_add_u32 s58, s58, 1
    s_cmp_lg_u32 s46, 0
    s_cbranch_scc1 A_NOXP
    v_mov_b32 v104, s58
    v_mov_b32 v105, s69
    v_mov_b32 v106, s58
    v_mov_b32 v107, s58
    s_lshl_b32 s49, s44, 5
    s_add_u32 s49, s49, s45
    s_lshl_b32 s49, s49, 7
    s_add_u32 s49, s49, 720896
    s_mov_b64 exec, 0xff
    buffer_store_dwordx4 v[104:107], v27, s[40:43], s49 offen sc1
    s_mov_b64 exec, -1
A_NOXP:
    s_cmp_eq_u32 s47, 0
    s_cselect_b32 s49, 16, 0
    s_lshl_b32 s56, s56, s49
    s_and_b32 s56, s56, 0xffff0000
    s_lshl_b32 s57, s57, s49
    s_and_b32 s57, s57, 0xffff0000
    v_mov_b32 v3, s56
    v_mov_b32 v7, 0x3fb8aa3b
    v_mul_f32 v4, v7, v3
    v_fma_f32 v5, v3, v7, -v4
    v_fmac_f32 v5, 0x32a57060, v3
    v_exp_f32 v4, v4
    v_mul_f32 v5, 0x3f317218, v5
    v_fmac_f32 v4, v4, v5
    v_cvt_pk_bf16_f32 v4, v4, v4
    v_and_b32 v36, 0xffff0000, v4
    s_waitcnt vmcnt(7)
    v_lshlrev_b32 v12, 16, v12
    s_waitcnt vmcnt(6)
    v_lshlrev_b32 v13, 16, v13
    s_waitcnt vmcnt(5)
    v_lshlrev_b32 v14, 16, v14
    s_waitcnt vmcnt(4)
    v_lshlrev_b32 v15, 16, v15
    s_waitcnt vmcnt(3)
    v_lshlrev_b32 v16, 16, v16
    s_waitcnt vmcnt(2)
    v_lshlrev_b32 v17, 16, v17
    v_mul_f32 v12, v12, v36
    v_mul_f32 v13, v13, v36
    v_mul_f32 v14, v14, v36
    v_mul_f32 v15, v15, v36
    v_mul_f32 v40, v16, v14
    v_mul_f32 v41, v16, v15
    v_fma_f32 v40, -v17, v15, v40
    v_fmac_f32 v41, v17, v14
    v_mul_f32 v12, 0x3fb8aa3b, v12
    v_mul_f32 v13, 0.15915494, v13
    v_exp_f32 v3, v12
    v_fract_f32 v4, v13
    v_cos_f32 v5, v4
    v_sin_f32 v6, v4
    v_mul_f32 v56, v3, v5
    v_mul_f32 v57, v3, v6
    v_mul_f32 v3, 0x41000000, v12
    v_mul_f32 v4, 0x41000000, v13
    v_exp_f32 v3, v3
    v_fract_f32 v4, v4
    v_cos_f32 v5, v4
    v_sin_f32 v6, v4
    v_mul_f32 v58, v3, v5
    v_mul_f32 v59, v3, v6
    v_mul_f32 v3, 0x43000000, v12
    v_mul_f32 v4, 0x43000000, v13
    v_exp_f32 v3, v3
    v_fract_f32 v4, v4
    v_cos_f32 v5, v4
    v_sin_f32 v6, v4
    v_mul_f32 v60, v3, v5
    v_mul_f32 v61, v3, v6
    s_mul_i32 s49, s47, 31008
    s_lshl_b32 s50, s48, 8
    s_add_u32 s49, s49, s50
    v_lshl_add_u32 v26, v2, 2, s49
    s_mov_b32 m0, s49
    v_cvt_pk_bf16_f32 v76, v40, v41
    v_mov_b32 v84, 0x3f80
    ds_write_addtid_b32 v76 offset:0
    ds_write_addtid_b32 v84 offset:22304
    v_mul_f32 v70, v41, v57
    v_mov_b32 v62, v58
    v_mul_f32 v71, v40, v57
    v_xor_b32 v63, 0x80000000, v59
    v_fma_f32 v42, v40, v56, -v70
    v_cvt_pk_bf16_f32 v85, v62, v63
    v_fma_f32 v43, v41, v56, v71
    ds_write_addtid_b32 v85 offset:22848
    v_cvt_pk_bf16_f32 v77, v42, v43
    ds_write_addtid_b32 v77 offset:544
    v_mul_f32 v68, v43, v57
    v_mul_f32 v80, v63, v59
    v_mul_f32 v69, v42, v57
    v_mul_f32 v81, v62, v59
    v_fma_f32 v44, v42, v56, -v68
    v_fma_f32 v62, v62, v58, v80
    v_fma_f32 v45, v43, v56, v69
    v_fma_f32 v63, v63, v58, -v81
    v_cvt_pk_bf16_f32 v78, v44, v45
    v_cvt_pk_bf16_f32 v84, v62, v63
    ds_write_addtid_b32 v78 offset:1088
    ds_write_addtid_b32 v84 offset:23392
    v_mul_f32 v70, v45, v57
    v_mul_f32 v80, v63, v59
    v_mul_f32 v71, v44, v57
    v_mul_f32 v81, v62, v59
    v_fma_f32 v46, v44, v56, -v70
    v_fma_f32 v62, v62, v58, v80
    v_fma_f32 v47, v45, v56, v71
    v_fma_f32 v63, v63, v58, -v81
    v_cvt_pk_bf16_f32 v79, v46, v47
    v_cvt_pk_bf16_f32 v85, v62, v63
    ds_write_addtid_b32 v79 offset:1632
    ds_write_addtid_b32 v85 offset:23936
    v_mul_f32 v68, v47, v57
    v_mul_f32 v80, v63, v59
    v_mul_f32 v69, v46, v57
    v_mul_f32 v81, v62, v59
    v_fma_f32 v48, v46, v56, -v68
    v_fma_f32 v62, v62, v58, v80
    v_fma_f32 v49, v47, v56, v69
    v_fma_f32 v63, v63, v58, -v81
    v_cvt_pk_bf16_f32 v76, v48, v49
    v_cvt_pk_bf16_f32 v84, v62, v63
    ds_write_addtid_b32 v76 offset:2176
    ds_write_addtid_b32 v84 offset:24480
    v_mul_f32 v70, v49, v57
    v_mul_f32 v80, v63, v59
    v_mul_f32 v71, v48, v57
    v_mul_f32 v81, v62, v59
    v_fma_f32 v50, v48, v56, -v70
    v_fma_f32 v62, v62, v58, v80
    v_fma_f32 v51, v49, v56, v71
    v_fma_f32 v63, v63, v58, -v81
    v_cvt_pk_bf16_f32 v77, v50, v51
    v_cvt_pk_bf16_f32 v85, v62, v63
    ds_write_addtid_b32 v77 offset:2720
    ds_write_addtid_b32 v85 offset:25024
    v_mul_f32 v68, v51, v57
    v_mul_f32 v80, v63, v59
    v_mul_f32 v69, v50, v57
    v_mul_f32 v81, v62, v59
    v_fma_f32 v52, v50, v56, -v68
    v_fma_f32 v62, v62, v58, v80
    v_fma_f32 v53, v51, v56, v69
    v_fma_f32 v63, v63, v58, -v81
    v_cvt_pk_bf16_f32 v78, v52, v53
    v_cvt_pk_bf16_f32 v84, v62, v63
    ds_write_addtid_b32 v78 offset:3264
    ds_write_addtid_b32 v84 offset:25568
    v_mul_f32 v70, v53, v57
    v_mul_f32 v80, v63, v59
    v_mul_f32 v71, v52, v57
    v_mul_f32 v81, v62, v59
    v_fma_f32 v54, v52, v56, -v70
    v_fma_f32 v62, v62, v58, v80
    v_fma_f32 v55, v53, v56, v71
    v_fma_f32 v63, v63, v58, -v81
    v_cvt_pk_bf16_f32 v79, v54, v55
    v_cvt_pk_bf16_f32 v85, v62, v63
    ds_write_addtid_b32 v79 offset:3808
    ds_write_addtid_b32 v85 offset:26112
    v_mul_f32 v68, v41, v61
    v_mul_f32 v70, v43, v61
    v_mul_f32 v69, v40, v61
    v_mul_f32 v71, v42, v61
    v_fma_f32 v40, v40, v60, -v68
    v_fma_f32 v42, v42, v60, -v70
    v_fma_f32 v41, v41, v60, v69
    v_fma_f32 v43, v43, v60, v71
    v_cvt_pk_bf16_f32 v76, v40, v41
    v_cvt_pk_bf16_f32 v77, v42, v43
    ds_write_addtid_b32 v76 offset:4352
    ds_write_addtid_b32 v77 offset:4896
    v_mul_f32 v68, v45, v61
    v_mul_f32 v70, v47, v61
    v_mul_f32 v69, v44, v61
    v_mul_f32 v71, v46, v61
    v_fma_f32 v44, v44, v60, -v68
    v_fma_f32 v46, v46, v60, -v70
    v_fma_f32 v45, v45, v60, v69
    v_fma_f32 v47, v47, v60, v71
    v_cvt_pk_bf16_f32 v78, v44, v45
    v_cvt_pk_bf16_f32 v79, v46, v47
    ds_write_addtid_b32 v78 offset:5440
    ds_write_addtid_b32 v79 offset:5984
    v_mul_f32 v68, v49, v61
    v_mul_f32 v70, v51, v61
    v_mul_f32 v69, v48, v61
    v_mul_f32 v71, v50, v61
    v_fma_f32 v48, v48, v60, -v68
    v_fma_f32 v50, v50, v60, -v70
    v_fma_f32 v49, v49, v60, v69
    v_fma_f32 v51, v51, v60, v71
    v_cvt_pk_bf16_f32 v76, v48, v49
    v_cvt_pk_bf16_f32 v77, v50, v51
    ds_write_addtid_b32 v76 offset:6528
    ds_write_addtid_b32 v77 offset:7072
    v_mul_f32 v68, v53, v61
    v_mul_f32 v70, v55, v61
    v_mul_f32 v69, v52, v61
    v_mul_f32 v71, v54, v61
    v_fma_f32 v52, v52, v60, -v68
    v_fma_f32 v54, v54, v60, -v70
    v_fma_f32 v53, v53, v60, v69
    v_fma_f32 v55, v55, v60, v71
    v_cvt_pk_bf16_f32 v78, v52, v53
    v_cvt_pk_bf16_f32 v79, v54, v55
    ds_write_addtid_b32 v78 offset:7616
    ds_write_addtid_b32 v79 offset:8160
    v_mul_f32 v68, v41, v61
    v_mul_f32 v70, v45, v61
    v_mul_f32 v69, v40, v61
    v_mul_f32 v71, v44, v61
    v_fma_f32 v40, v40, v60, -v68
    v_fma_f32 v44, v44, v60, -v70
    v_fma_f32 v41, v41, v60, v69
    v_fma_f32 v45, v45, v60, v71
    v_cvt_pk_bf16_f32 v76, v40, v41
    v_cvt_pk_bf16_f32 v77, v44, v45
    ds_write_addtid_b32 v76 offset:8704
    ds_write_addtid_b32 v77 offset:9248
    v_mul_f32 v68, v49, v61
    v_mul_f32 v70, v53, v61
    v_mul_f32 v69, v48, v61
    v_mul_f32 v71, v52, v61
    v_fma_f32 v48, v48, v60, -v68
    v_fma_f32 v52, v52, v60, -v70
    v_fma_f32 v49, v49, v60, v69
    v_fma_f32 v53, v53, v60, v71
    v_cvt_pk_bf16_f32 v78, v48, v49
    v_cvt_pk_bf16_f32 v79, v52, v53
    ds_write_addtid_b32 v78 offset:9792
    ds_write_addtid_b32 v79 offset:10336
    v_mul_f32 v68, v41, v61
    v_mul_f32 v70, v45, v61
    v_mul_f32 v69, v40, v61
    v_mul_f32 v71, v44, v61
    v_fma_f32 v40, v40, v60, -v68
    v_fma_f32 v44, v44, v60, -v70
    v_fma_f32 v41, v41, v60, v69
    v_fma_f32 v45, v45, v60, v71
    v_cvt_pk_bf16_f32 v76, v40, v41
    v_cvt_pk_bf16_f32 v77, v44, v45
    ds_write_addtid_b32 v76 offset:10880
    ds_write_addtid_b32 v77 offset:11424
    v_mul_f32 v68, v49, v61
    v_mul_f32 v70, v53, v61
    v_mul_f32 v69, v48, v61
    v_mul_f32 v71, v52, v61
    v_fma_f32 v48, v48, v60, -v68
    v_fma_f32 v52, v52, v60, -v70
    v_fma_f32 v49, v49, v60, v69
    v_fma_f32 v53, v53, v60, v71
    v_cvt_pk_bf16_f32 v78, v48, v49
    v_cvt_pk_bf16_f32 v79, v52, v53
    ds_write_addtid_b32 v78 offset:11968
    ds_write_addtid_b32 v79 offset:12512
    v_mul_f32 v68, v41, v61
    v_mul_f32 v70, v49, v61
    v_mul_f32 v69, v40, v61
    v_mul_f32 v71, v48, v61
    v_fma_f32 v40, v40, v60, -v68
    v_fma_f32 v48, v48, v60, -v70
    v_fma_f32 v41, v41, v60, v69
    v_fma_f32 v49, v49, v60, v71
    v_cvt_pk_bf16_f32 v76, v40, v41
    v_cvt_pk_bf16_f32 v77, v48, v49
    ds_write_addtid_b32 v76 offset:21760
    ds_write_addtid_b32 v77 offset:13056
    v_mul_f32 v68, v41, v59
    v_mul_f32 v69, v40, v59
    v_fma_f32 v40, v40, v58, -v68
    v_fma_f32 v41, v41, v58, v69
    v_cvt_pk_bf16_f32 v78, v40, v41
    ds_write_addtid_b32 v78 offset:13600
    v_mul_f32 v70, v49, v61
    v_mul_f32 v68, v41, v61
    v_mul_f32 v71, v48, v61
    v_mul_f32 v69, v40, v61
    v_fma_f32 v48, v48, v60, -v70
    v_fma_f32 v40, v40, v60, -v68
    v_fma_f32 v49, v49, v60, v71
    v_fma_f32 v41, v41, v60, v69
    v_cvt_pk_bf16_f32 v79, v48, v49
    v_cvt_pk_bf16_f32 v76, v40, v41
    ds_write_addtid_b32 v79 offset:14144
    ds_write_addtid_b32 v76 offset:14688
    v_mul_f32 v70, v49, v61
    v_mul_f32 v68, v41, v61
    v_mul_f32 v71, v48, v61
    v_mul_f32 v69, v40, v61
    v_fma_f32 v48, v48, v60, -v70
    v_fma_f32 v40, v40, v60, -v68
    v_fma_f32 v49, v49, v60, v71
    v_fma_f32 v41, v41, v60, v69
    v_cvt_pk_bf16_f32 v77, v48, v49
    v_cvt_pk_bf16_f32 v78, v40, v41
    ds_write_addtid_b32 v77 offset:15232
    ds_write_addtid_b32 v78 offset:15776
    v_mul_f32 v70, v49, v61
    v_mul_f32 v68, v41, v61
    v_mul_f32 v71, v48, v61
    v_mul_f32 v69, v40, v61
    v_fma_f32 v48, v48, v60, -v70
    v_fma_f32 v40, v40, v60, -v68
    v_fma_f32 v49, v49, v60, v71
    v_fma_f32 v41, v41, v60, v69
    v_cvt_pk_bf16_f32 v79, v48, v49
    v_cvt_pk_bf16_f32 v76, v40, v41
    ds_write_addtid_b32 v79 offset:16320
    ds_write_addtid_b32 v76 offset:16864
    v_mul_f32 v70, v41, v61
    v_mul_f32 v80, v63, v59
    v_mul_f32 v71, v40, v61
    v_mul_f32 v81, v62, v59
    v_fma_f32 v40, v40, v60, -v70
    v_fma_f32 v62, v62, v58, v80
    v_fma_f32 v41, v41, v60, v71
    v_fma_f32 v63, v63, v58, -v81
    v_cvt_pk_bf16_f32 v77, v40, v41
    v_cvt_pk_bf16_f32 v84, v62, v63
    ds_write_addtid_b32 v77 offset:17408
    ds_write_addtid_b32 v84 offset:26656
    v_mul_f32 v68, v41, v61
    v_mul_f32 v80, v63, v59
    v_mul_f32 v69, v40, v61
    v_mul_f32 v81, v62, v59
    v_fma_f32 v40, v40, v60, -v68
    v_fma_f32 v62, v62, v58, v80
    v_fma_f32 v41, v41, v60, v69
    v_fma_f32 v63, v63, v58, -v81
    v_cvt_pk_bf16_f32 v78, v40, v41
    v_cvt_pk_bf16_f32 v85, v62, v63
    ds_write_addtid_b32 v78 offset:17952
    ds_write_addtid_b32 v85 offset:27200
    v_mul_f32 v70, v41, v61
    v_mul_f32 v80, v63, v59
    v_mul_f32 v71, v40, v61
    v_mul_f32 v81, v62, v59
    v_fma_f32 v40, v40, v60, -v70
    v_fma_f32 v62, v62, v58, v80
    v_fma_f32 v41, v41, v60, v71
    v_fma_f32 v63, v63, v58, -v81
    v_cvt_pk_bf16_f32 v79, v40, v41
    v_cvt_pk_bf16_f32 v84, v62, v63
    ds_write_addtid_b32 v79 offset:18496
    ds_write_addtid_b32 v84 offset:27744
    v_mul_f32 v68, v41, v61
    v_mul_f32 v80, v63, v59
    v_mul_f32 v69, v40, v61
    v_mul_f32 v81, v62, v59
    v_fma_f32 v40, v40, v60, -v68
    v_fma_f32 v62, v62, v58, v80
    v_fma_f32 v41, v41, v60, v69
    v_fma_f32 v63, v63, v58, -v81
    v_cvt_pk_bf16_f32 v76, v40, v41
    v_cvt_pk_bf16_f32 v85, v62, v63
    ds_write_addtid_b32 v76 offset:19040
    ds_write_addtid_b32 v85 offset:28288
    v_mul_f32 v70, v41, v61
    v_mul_f32 v80, v63, v59
    v_mul_f32 v71, v40, v61
    v_mul_f32 v81, v62, v59
    v_fma_f32 v40, v40, v60, -v70
    v_fma_f32 v62, v62, v58, v80
    v_fma_f32 v41, v41, v60, v71
    v_fma_f32 v63, v63, v58, -v81
    v_cvt_pk_bf16_f32 v77, v40, v41
    v_cvt_pk_bf16_f32 v84, v62, v63
    ds_write_addtid_b32 v77 offset:19584
    ds_write_addtid_b32 v84 offset:28832
    v_mul_f32 v68, v41, v61
    v_mul_f32 v80, v63, v59
    v_mul_f32 v69, v40, v61
    v_mul_f32 v81, v62, v59
    v_fma_f32 v40, v40, v60, -v68
    v_fma_f32 v62, v62, v58, v80
    v_fma_f32 v41, v41, v60, v69
    v_fma_f32 v63, v63, v58, -v81
    v_cvt_pk_bf16_f32 v78, v40, v41
    v_cvt_pk_bf16_f32 v85, v62, v63
    ds_write_addtid_b32 v78 offset:20128
    ds_write_addtid_b32 v85 offset:29376
    v_mul_f32 v70, v41, v61
    v_mul_f32 v80, v63, v59
    v_mul_f32 v71, v40, v61
    v_mul_f32 v81, v62, v59
    v_fma_f32 v40, v40, v60, -v70
    v_fma_f32 v62, v62, v58, v80
    v_fma_f32 v41, v41, v60, v71
    v_fma_f32 v63, v63, v58, -v81
    v_cvt_pk_bf16_f32 v79, v40, v41
    v_cvt_pk_bf16_f32 v84, v62, v63
    ds_write_addtid_b32 v79 offset:20672
    ds_write_addtid_b32 v84 offset:29920
    v_mul_f32 v68, v41, v61
    v_mul_f32 v80, v63, v59
    v_mul_f32 v69, v40, v61
    v_mul_f32 v81, v62, v59
    v_fma_f32 v40, v40, v60, -v68
    v_fma_f32 v62, v62, v58, v80
    v_fma_f32 v41, v41, v60, v69
    v_fma_f32 v63, v63, v58, -v81
    v_cvt_pk_bf16_f32 v76, v40, v41
    v_cvt_pk_bf16_f32 v85, v62, v63
    ds_write_addtid_b32 v76 offset:21216
    ds_write_addtid_b32 v85 offset:30464
    s_setprio 0
    v_bfe_u32 v114, v0, 4, 2
    v_and_b32 v112, 15, v0
    v_lshlrev_b32 v114, 3, v114
    v_sub_u32 v116, v114, v112
    v_add_u32 v116, 16, v116
    s_mov_b32 s49, 0x10001
    s_mov_b32 s60, 0x38000000
    s_mov_b32 s61, 0
    v_lshrrev_b64 v[112:113], v116, s[60:61]
    v_and_b32 v115, 0xaa, v112
    v_and_b32 v112, 0x55, v112
    v_lshl_or_b32 v112, v115, 15, v112
    v_and_b32 v115, s49, v112
    v_mul_u32_u24 v224, 0x3f80, v115
    v_lshrrev_b32 v115, 2, v112
    v_and_b32 v115, s49, v115
    v_mul_u32_u24 v225, 0x3f80, v115
    v_lshrrev_b32 v115, 4, v112
    v_and_b32 v115, s49, v115
    v_mul_u32_u24 v226, 0x3f80, v115
    v_lshrrev_b32 v115, 6, v112
    v_and_b32 v115, s49, v115
    v_mul_u32_u24 v227, 0x3f80, v115
    s_mov_b32 s60, 0x7c00000
    s_mov_b32 s61, 0
    v_lshrrev_b64 v[112:113], v116, s[60:61]
    v_and_b32 v115, 0xaa, v112
    v_and_b32 v112, 0x55, v112
    v_lshl_or_b32 v112, v115, 15, v112
    v_and_b32 v115, s49, v112
    v_mul_u32_u24 v228, 0x3f80, v115
    v_lshrrev_b32 v115, 2, v112
    v_and_b32 v115, s49, v115
    v_mul_u32_u24 v229, 0x3f80, v115
    v_lshrrev_b32 v115, 4, v112
    v_and_b32 v115, s49, v115
    v_mul_u32_u24 v230, 0x3f80, v115
    v_lshrrev_b32 v115, 6, v112
    v_and_b32 v115, s49, v115
    v_mul_u32_u24 v231, 0x3f80, v115
    s_mov_b32 s60, 0x380000
    s_mov_b32 s61, 0
    v_lshrrev_b64 v[112:113], v116, s[60:61]
    v_and_b32 v115, 0xaa, v112
    v_and_b32 v112, 0x55, v112
    v_lshl_or_b32 v112, v115, 15, v112
    v_and_b32 v115, s49, v112
    v_mul_u32_u24 v232, 0x3f80, v115
    v_lshrrev_b32 v115, 2, v112
    v_and_b32 v115, s49, v115
    v_mul_u32_u24 v233, 0x3f80, v115
    v_lshrrev_b32 v115, 4, v112
    v_and_b32 v115, s49, v115
    v_mul_u32_u24 v234, 0x3f80, v115
    v_lshrrev_b32 v115, 6, v112
    v_and_b32 v115, s49, v115
    v_mul_u32_u24 v235, 0x3f80, v115
    s_mov_b32 s60, 0xfe00000
    s_mov_b32 s61, 0
    v_lshrrev_b64 v[112:113], v116, s[60:61]
    v_and_b32 v115, 0xaa, v112
    v_and_b32 v112, 0x55, v112
    v_lshl_or_b32 v112, v115, 15, v112
    v_and_b32 v115, s49, v112
    v_mul_u32_u24 v240, 0x3f80, v115
    v_lshrrev_b32 v115, 2, v112
    v_and_b32 v115, s49, v115
    v_mul_u32_u24 v241, 0x3f80, v115
    v_lshrrev_b32 v115, 4, v112
    v_and_b32 v115, s49, v115
    v_mul_u32_u24 v242, 0x3f80, v115
    v_lshrrev_b32 v115, 6, v112
    v_and_b32 v115, s49, v115
    v_mul_u32_u24 v243, 0x3f80, v115
    s_mov_b32 s60, 0x1ff00000
    s_mov_b32 s61, 0
    v_lshrrev_b64 v[112:113], v116, s[60:61]
    v_and_b32 v115, 0xaa, v112
    v_and_b32 v112, 0x55, v112
    v_lshl_or_b32 v112, v115, 15, v112
    v_and_b32 v115, s49, v112
    v_mul_u32_u24 v244, 0x3f80, v115
    v_lshrrev_b32 v115, 2, v112
    v_and_b32 v115, s49, v115
    v_mul_u32_u24 v245, 0x3f80, v115
    v_lshrrev_b32 v115, 4, v112
    v_and_b32 v115, s49, v115
    v_mul_u32_u24 v246, 0x3f80, v115
    v_lshrrev_b32 v115, 6, v112
    v_and_b32 v115, s49, v115
    v_mul_u32_u24 v247, 0x3f80, v115
    s_mov_b32 s60, 0x7f00000
    s_mov_b32 s61, 0
    v_lshrrev_b64 v[112:113], v116, s[60:61]
    v_and_b32 v115, 0xaa, v112
    v_and_b32 v112, 0x55, v112
    v_lshl_or_b32 v112, v115, 15, v112
    v_and_b32 v115, s49, v112
    v_mul_u32_u24 v248, 0xffff, v115
    v_lshrrev_b32 v115, 2, v112
    v_and_b32 v115, s49, v115
    v_mul_u32_u24 v249, 0xffff, v115
    v_lshrrev_b32 v115, 4, v112
    v_and_b32 v115, s49, v115
    v_mul_u32_u24 v250, 0xffff, v115
    v_lshrrev_b32 v115, 6, v112
    v_and_b32 v115, s49, v115
    v_mul_u32_u24 v251, 0xffff, v115
    s_waitcnt vmcnt(0)
    v_and_b32 v108, 31, v0
    v_lshlrev_b32 v108, 7, v108
    s_lshl_b32 s73, s44, 12
    s_add_u32 s73, s73, 720896
    s_mov_b32 s68, 0
    buffer_load_dwordx2 v[110:111], v108, s[40:43], s73 offen sc1
    s_waitcnt lgkmcnt(0)
    s_barrier
    ds_read_b64_tr_b16 v[96:97], v21 offset:0
    ds_read_b64_tr_b16 v[98:99], v21 offset:512
    ds_read_b64_tr_b16 v[100:101], v21 offset:1024
    ds_read_b64_tr_b16 v[102:103], v21 offset:1536
    s_waitcnt lgkmcnt(0)
    ds_write_b128 v22, v[96:99]
    ds_write_b128 v23, v[100:103]
    s_waitcnt lgkmcnt(0)
    s_barrier
    ds_read_b128 v[96:99], v24 offset:8192
    ds_read_b128 v[100:103], v24 offset:12288
    v_mov_b32 v92, 0
    v_mov_b32 v93, 0
    v_mov_b32 v94, 0
    v_mov_b32 v95, 0
    ds_write_b128 v24, v[92:95]
    ds_write_b128 v24, v[92:95] offset:4096
A_X_CHK:
    s_waitcnt vmcnt(0)
    v_cmp_ne_u32 vcc, s58, v110
    s_nop 0
    s_cbranch_vccnz A_X_AGAIN
A_X_OK:
    v_cmp_ne_u32 vcc, s69, v111
    s_nop 0
    s_or_b32 s70, vcc_lo, vcc_hi
    s_waitcnt lgkmcnt(2)
    s_cmp_eq_u32 s70, 0
    s_cbranch_scc0 A_SM0a
    buffer_store_dwordx4 v[96:99], v25, s[36:39], s71 offen
    buffer_store_dwordx4 v[100:103], v25, s[36:39], s72 offen
    s_branch A_SM0b
A_SM0a:
    buffer_store_dwordx4 v[96:99], v25, s[36:39], s71 offen sc1
    buffer_store_dwordx4 v[100:103], v25, s[36:39], s72 offen sc1
A_SM0b:
    v_and_b32 v4, 15, v0
    v_mul_u32_u24 v3, 544, v4
    v_bfe_u32 v5, v0, 4, 2
    v_lshl_add_u32 v3, v5, 4, v3
    s_mul_i32 s49, s47, 31008
    v_add_u32 v3, s49, v3
    s_waitcnt vmcnt(0) lgkmcnt(0)
    s_barrier
    s_cmp_lg_u32 s46, 0
    s_cbranch_scc1 A_NOFLAG
    v_mov_b32 v12, s58
    v_mov_b32 v13, s69
    v_mov_b32 v14, s58
    v_mov_b32 v15, s58
    s_lshl_b32 s49, s44, 5
    s_add_u32 s49, s49, s45
    s_lshl_b32 s49, s49, 4
    s_add_u32 s49, s49, 4096
    s_mov_b64 exec, 1
    s_cmp_eq_u32 s70, 0
    s_cbranch_scc0 A_SM1a
    buffer_store_dwordx4 v[12:15], v27, s[40:43], s49 offen
    s_branch A_SM1b
A_SM1a:
    buffer_store_dwordx4 v[12:15], v27, s[40:43], s49 offen sc1
A_SM1b:
    s_mov_b64 exec, -1
A_NOFLAG:
    s_cmp_lg_u32 s48, 0
    s_cbranch_scc1 A_KG1
    ds_read_b128 v[44:47], v3 offset:22304
    ds_read_b128 v[48:51], v3 offset:8704
    ds_read_b128 v[52:55], v3 offset:0
    ds_read_b128 v[56:59], v3 offset:22368
    ds_read_b128 v[60:63], v3 offset:8768
    ds_read_b128 v[64:67], v3 offset:64
    ds_read_b128 v[68:71], v3 offset:22432
    ds_read_b128 v[72:75], v3 offset:8832
    ds_read_b128 v[76:79], v3 offset:128
    ds_read_b128 v[80:83], v3 offset:22496
    ds_read_b128 v[84:87], v3 offset:8896
    ds_read_b128 v[88:91], v3 offset:192
    v_lshrrev_b32 v6, 1, v5
    v_lshlrev_b32 v6, 5, v6
    v_and_b32 v7, 1, v5
    v_add_u32 v6, v6, v7
    v_lshl_add_u32 v6, v4, 1, v6
    v_lshlrev_b32 v6, 3, v6
    s_add_u32 s49, s66, 1064
    v_sub_u32 v6, s49, v6
    v_lshlrev_b32 v7, 4, v5
    v_add_u32 v7, v7, v4
    v_lshlrev_b32 v7, 4, v7
    s_add_u32 s49, s66, 544
    v_sub_u32 v7, s49, v7
    v_lshlrev_b32 v8, 5, v5
    v_add_u32 v8, v8, v4
    v_lshlrev_b32 v8, 2, v8
    s_add_u32 s49, s66, 2240
    v_add_u32 v8, s49, v8
    v_mov_b32 v9, 0
    v_mov_b32 v10, s57
    s_mov_b64 s[60:61], 1
    v_cndmask_b32 v9, v9, v10, s[60:61]
    s_waitcnt lgkmcnt(10)
    v_mfma_f32_16x16x32_bf16 v[32:35], v[48:51], v[44:47], 0
    s_waitcnt lgkmcnt(9)
    v_mfma_f32_16x16x32_bf16 v[28:31], v[52:55], v[44:47], 0
    ds_read_b128 v[44:47], v3 offset:22560
    ds_read_b128 v[48:51], v3 offset:8960
    ds_read_b128 v[52:55], v3 offset:256
    s_waitcnt lgkmcnt(10)
    v_mfma_f32_16x16x32_bf16 v[32:35], v[60:63], v[56:59], v[32:35]
    s_waitcnt lgkmcnt(9)
    v_mfma_f32_16x16x32_bf16 v[28:31], v[64:67], v[56:59], v[28:31]
    ds_read_b128 v[56:59], v3 offset:22624
    ds_read_b128 v[60:63], v3 offset:9024
    ds_read_b128 v[64:67], v3 offset:320
    s_waitcnt lgkmcnt(10)
    v_mfma_f32_16x16x32_bf16 v[32:35], v[72:75], v[68:71], v[32:35]
    s_waitcnt lgkmcnt(9)
    v_mfma_f32_16x16x32_bf16 v[28:31], v[76:79], v[68:71], v[28:31]
    ds_read_b128 v[68:71], v3 offset:22688
    ds_read_b128 v[72:75], v3 offset:9088
    ds_read_b128 v[76:79], v3 offset:384
    s_waitcnt lgkmcnt(10)
    v_mfma_f32_16x16x32_bf16 v[32:35], v[84:87], v[80:83], v[32:35]
    s_waitcnt lgkmcnt(9)
    v_mfma_f32_16x16x32_bf16 v[28:31], v[88:91], v[80:83], v[28:31]
    ds_read_b128 v[80:83], v3 offset:22752
    ds_read_b128 v[84:87], v3 offset:9152
    ds_read_b128 v[88:91], v3 offset:448
    s_waitcnt lgkmcnt(10)
    v_mfma_f32_16x16x32_bf16 v[32:35], v[48:51], v[44:47], v[32:35]
    s_waitcnt lgkmcnt(9)
    v_mfma_f32_16x16x32_bf16 v[28:31], v[52:55], v[44:47], v[28:31]
    s_waitcnt lgkmcnt(7)
    v_mfma_f32_16x16x32_bf16 v[32:35], v[60:63], v[56:59], v[32:35]
    s_waitcnt lgkmcnt(6)
    v_mfma_f32_16x16x32_bf16 v[28:31], v[64:67], v[56:59], v[28:31]
    s_waitcnt lgkmcnt(4)
    v_mfma_f32_16x16x32_bf16 v[32:35], v[72:75], v[68:71], v[32:35]
    s_waitcnt lgkmcnt(3)
    v_mfma_f32_16x16x32_bf16 v[28:31], v[76:79], v[68:71], v[28:31]
    s_waitcnt lgkmcnt(1)
    v_mfma_f32_16x16x32_bf16 v[32:35], v[84:87], v[80:83], v[32:35]
    s_waitcnt lgkmcnt(0)
    v_mfma_f32_16x16x32_bf16 v[28:31], v[88:91], v[80:83], v[28:31]
    s_nop 5
    v_cvt_pk_bf16_f32 v12, v34, v34
    v_cvt_pk_bf16_f32 v13, v33, v32
    v_cvt_pk_bf16_f32 v14, v34, v33
    v_cvt_pk_bf16_f32 v15, v32, v32
    v_cvt_pk_bf16_f32 v16, v35, v34
    v_cvt_pk_bf16_f32 v17, v35, v35
    s_mov_b32 exec_hi, 0
    ds_write_b16 v7, v16 offset:2
    ds_write_b32 v7, v12 offset:4
    ds_write_b64 v7, v[14:15] offset:8
    ds_write_b16 v7, v15 offset:16
    ds_write_b32 v7, v16 offset:1220
    ds_write_b64 v7, v[12:13] offset:1224
    ds_write_b32 v7, v15 offset:1232
    s_mov_b32 exec_lo, 0
    s_mov_b32 exec_hi, 0x80000000
    v_mov_b32 v18, s66
    ds_write_b32 v18, v17 offset:3200
    v_mov_b32 v35, 0
    s_mov_b32 exec_hi, -1
    v_cvt_pk_bf16_f32 v12, v32, v33
    v_cvt_pk_bf16_f32 v13, v34, v35
    ds_write_b32 v8, v12
    ds_write_b32 v8, v13 offset:64
    s_mov_b32 exec_lo, -1
    v_add_f32 v28, v28, v9
    v_cvt_pk_bf16_f32 v14, v31, v30
    v_cvt_pk_bf16_f32 v15, v29, v28
    v_cvt_pk_bf16_f32 v16, v30, v29
    ds_write_b64 v6, v[14:15]
    ds_write_b16 v6, v14 offset:1218
    ds_write_b32 v6, v16 offset:1220
    ds_write_b16_d16_hi v6, v15 offset:1224
    s_branch A_KG2
A_KG1:
    ds_read_b128 v[44:47], v3 offset:22304
    ds_read_b128 v[48:51], v3 offset:17408
    ds_read_b128 v[52:55], v3 offset:22368
    ds_read_b128 v[56:59], v3 offset:17472
    ds_read_b128 v[60:63], v3 offset:22432
    ds_read_b128 v[64:67], v3 offset:17536
    ds_read_b128 v[68:71], v3 offset:22496
    ds_read_b128 v[72:75], v3 offset:17600
    ds_read_b128 v[76:79], v3 offset:22560
    ds_read_b128 v[80:83], v3 offset:17664
    ds_read_b128 v[84:87], v3 offset:22624
    ds_read_b128 v[88:91], v3 offset:17728
    v_mov_b32 v17, 4624
    s_mov_b32 s60, 0
    s_mov_b32 s61, 2
    v_cndmask_b32 v16, v27, v17, s[60:61]
    v_add_u32 v16, s67, v16
    s_mov_b32 exec_hi, 3
    ds_write_b128 v16, v[92:95]
    s_mov_b32 exec_hi, -1
    v_lshlrev_b32 v8, 2, v4
    v_add_u32 v8, v8, v5
    v_lshlrev_b32 v8, 3, v8
    s_add_u32 s49, s66, 2944
    v_add_u32 v8, s49, v8
    s_waitcnt lgkmcnt(11)
    v_mfma_f32_16x16x32_bf16 v[28:31], v[44:47], v[48:51], 0
    ds_read_b128 v[44:47], v3 offset:22688
    ds_read_b128 v[48:51], v3 offset:17792
    s_waitcnt lgkmcnt(11)
    v_mfma_f32_16x16x32_bf16 v[28:31], v[52:55], v[56:59], v[28:31]
    ds_read_b128 v[52:55], v3 offset:22752
    ds_read_b128 v[56:59], v3 offset:17856
    s_waitcnt lgkmcnt(11)
    v_mfma_f32_16x16x32_bf16 v[28:31], v[60:63], v[64:67], v[28:31]
    s_waitcnt lgkmcnt(9)
    v_mfma_f32_16x16x32_bf16 v[28:31], v[68:71], v[72:75], v[28:31]
    s_waitcnt lgkmcnt(7)
    v_mfma_f32_16x16x32_bf16 v[28:31], v[76:79], v[80:83], v[28:31]
    s_waitcnt lgkmcnt(5)
    v_mfma_f32_16x16x32_bf16 v[28:31], v[84:87], v[88:91], v[28:31]
    s_waitcnt lgkmcnt(2)
    v_mfma_f32_16x16x32_bf16 v[28:31], v[44:47], v[48:51], v[28:31]
    s_waitcnt lgkmcnt(0)
    v_mfma_f32_16x16x32_bf16 v[28:31], v[52:55], v[56:59], v[28:31]
    v_mov_b32 v18, s66
    s_nop 6
    v_cvt_pk_bf16_f32 v12, v28, v29
    v_cvt_pk_bf16_f32 v13, v30, v31
    v_cvt_pk_bf16_f32 v14, v28, v28
    v_cvt_pk_bf16_f32 v15, v28, v28
    s_mov_b32 exec_lo, 0x00ff00ff
    s_mov_b32 exec_hi, 0x00ff00ff
    ds_write_b64 v8, v[12:13]
    s_mov_b64 exec, 0x100
    ds_write_b16 v18, v14 offset:42
    ds_write_b32 v18, v14 offset:44
    ds_write_b16 v18, v14 offset:48
    ds_write_b32 v18, v14 offset:1260
    ds_write_b32 v18, v14 offset:1264
    s_mov_b64 exec, -1
A_KG2:
    s_setprio 0
    s_waitcnt lgkmcnt(0)
    v_and_b32 v16, 31, v0
    v_lshlrev_b32 v16, 4, v16
    s_lshl_b32 s49, s44, 9
    s_add_u32 s49, s49, 4096
    s_mov_b32 s68, 0
    s_lshl1_add_u32 s50, s45, s47
    s_lshl_b32 s50, s50, 11
    s_lshl_b32 s51, s44, 7
    s_add_u32 s64, s50, s51
    s_lshl_b32 s50, s48, 21
    s_add_u32 s50, s50, s64
    s_add_u32 s65, s50, 0x100000
    v_lshrrev_b32 v14, 3, v2
    v_lshlrev_b32 v14, 17, v14
    v_and_b32 v15, 7, v0
    v_lshl_add_u32 v14, v15, 4, v14
    s_lshl_b32 s51, s48, 11
    s_add_u32 s51, s51, s67
    s_add_u32 m0, s51, 528
A_F_POLL:
    buffer_load_dwordx2 v[12:13], v16, s[40:43], s49 offen sc1
    s_add_u32 s68, s68, 1
    s_cmp_gt_u32 s68, 200000
    s_cbranch_scc1 A_F_GO
    s_waitcnt vmcnt(0)
    v_cmp_ne_u32 vcc, s58, v12
    s_nop 0
    s_cbranch_vccz A_F_GO
    s_sleep 4
    s_branch A_F_POLL
A_F_GO:
A_F_DMA:
    buffer_load_dwordx4 v14, s[36:39], s50 offen sc1 lds
    s_add_u32 m0, s51, 1552
    s_nop 0
    buffer_load_dwordx4 v14, s[36:39], s65 offen sc1 lds
    v_lshlrev_b32 v3, 1, v4
    v_add_u32 v3, v3, v5
    v_lshlrev_b32 v3, 4, v3
    v_add_u32 v3, s67, v3
    v_lshlrev_b32 v10, 3, v5
    v_sub_u32 v10, v10, v4
    v_lshlrev_b32 v10, 1, v10
    v_and_b32 v11, 1, v0
    v_mul_u32_u24 v11, 1218, v11
    v_sub_u32 v10, v10, v11
    s_add_u32 s49, s66, 1760
    v_add_u32 v6, s49, v10
    v_subrev_u32 v7, 512, v6
    v_lshlrev_b32 v10, 2, v5
    v_sub_u32 v10, v4, v10
    s_add_u32 s49, s66, 2376
    v_lshl_add_u32 v8, v10, 3, s49
    v_add_u32 v8, 96, v8
    s_add_u32 s49, s66, 2884
    v_lshl_add_u32 v9, v10, 2, s49
    v_add_u32 v9, 48, v9
    v_and_b32 v10, 1, v5
    v_lshrrev_b32 v11, 2, v4
    v_lshl_add_u32 v10, v10, 2, v11
    v_lshlrev_b32 v26, 17, v10
    v_lshrrev_b32 v10, 1, v5
    v_and_b32 v11, 3, v0
    v_lshl_add_u32 v10, v10, 2, v11
    v_lshl_add_u32 v26, v10, 4, v26
    s_lshl_b32 s49, s46, 12
    s_xor_b32 s50, s49, 4096
    v_add_u32 v252, s49, v27
    v_add_u32 v253, s50, v27
    s_waitcnt vmcnt(0)
    s_barrier
    s_cmp_lg_u32 s48, 0
    s_cbranch_scc1 A_CONV_P
    v_mov_b32 v18, s66
    ds_read_b32 v164, v18 offset:3200
    ds_read_b128 v[128:131], v3 offset:0
    ds_read2_b32 v[124:125], v7 offset0:0 offset1:1
    ds_read2_b32 v[126:127], v7 offset0:2 offset1:3
    ds_read_b128 v[132:135], v3 offset:512
    ds_read2_b32 v[120:121], v7 offset0:16 offset1:17
    ds_read2_b32 v[122:123], v7 offset0:18 offset1:19
    ds_read_b128 v[136:139], v3 offset:576
    ds_read2_b32 v[116:117], v7 offset0:32 offset1:33
    ds_read2_b32 v[118:119], v7 offset0:34 offset1:35
    ds_read_b128 v[140:143], v3 offset:640
    ds_read2_b32 v[112:113], v7 offset0:48 offset1:49
    ds_read2_b32 v[114:115], v7 offset0:50 offset1:51
    ds_read_b128 v[144:147], v3 offset:704
    ds_read2_b32 v[108:109], v7 offset0:64 offset1:65
    ds_read2_b32 v[110:111], v7 offset0:66 offset1:67
    s_waitcnt lgkmcnt(14)
    v_and_b32 v160, v248, v164
    v_and_b32 v161, v249, v164
    v_and_b32 v162, v250, v164
    v_and_b32 v163, v251, v164
    s_waitcnt lgkmcnt(14)
    s_nop 0
    v_mfma_f32_16x16x32_bf16 v[40:43], v[160:163], v[128:131], 0
    ds_read_b128 v[148:151], v3 offset:768
    ds_read2_b32 v[104:105], v7 offset0:80 offset1:81
    ds_read2_b32 v[106:107], v7 offset0:82 offset1:83
    s_waitcnt lgkmcnt(14)
    v_mfma_f32_16x16x32_bf16 v[36:39], v[124:127], v[132:135], 0
    ds_read_b128 v[152:155], v3 offset:832
    ds_read2_b32 v[100:101], v7 offset0:96 offset1:97
    ds_read2_b32 v[102:103], v7 offset0:98 offset1:99
    v_mfma_f32_16x16x32_bf16 v[44:47], v[160:163], v[132:135], 0
    s_waitcnt lgkmcnt(14)
    v_mfma_f32_16x16x32_bf16 v[36:39], v[120:123], v[136:139], v[36:39]
    ds_read_b128 v[156:159], v3 offset:896
    ds_read2_b32 v[96:97], v7 offset0:112 offset1:113
    ds_read2_b32 v[98:99], v7 offset0:114 offset1:115
    s_waitcnt lgkmcnt(14)
    v_mfma_f32_16x16x32_bf16 v[36:39], v[116:119], v[140:143], v[36:39]
    ds_read_b128 v[128:131], v3 offset:960
    ds_read2_b32 v[92:93], v6 offset0:0 offset1:1
    ds_read2_b32 v[94:95], v6 offset0:2 offset1:3
    s_waitcnt lgkmcnt(14)
    v_mfma_f32_16x16x32_bf16 v[36:39], v[112:115], v[144:147], v[36:39]
    ds_read_b128 v[132:135], v3 offset:1024
    ds_read2_b32 v[88:89], v6 offset0:16 offset1:17
    ds_read2_b32 v[90:91], v6 offset0:18 offset1:19
    s_waitcnt lgkmcnt(14)
    v_mfma_f32_16x16x32_bf16 v[36:39], v[108:111], v[148:151], v[36:39]
    ds_read_b128 v[136:139], v3 offset:1088
    ds_read2_b32 v[84:85], v6 offset0:32 offset1:33
    ds_read2_b32 v[86:87], v6 offset0:34 offset1:35
    s_waitcnt lgkmcnt(14)
    v_mfma_f32_16x16x32_bf16 v[36:39], v[104:107], v[152:155], v[36:39]
    ds_read_b128 v[140:143], v3 offset:1152
    ds_read2_b32 v[80:81], v6 offset0:48 offset1:49
    ds_read2_b32 v[82:83], v6 offset0:50 offset1:51
    s_waitcnt lgkmcnt(14)
    v_mfma_f32_16x16x32_bf16 v[36:39], v[100:103], v[156:159], v[36:39]
    ds_read_b128 v[144:147], v3 offset:1216
    ds_read2_b32 v[76:77], v6 offset0:64 offset1:65
    ds_read2_b32 v[78:79], v6 offset0:66 offset1:67
    s_waitcnt lgkmcnt(14)
    v_mfma_f32_16x16x32_bf16 v[36:39], v[96:99], v[128:131], v[36:39]
    ds_read_b128 v[148:151], v3 offset:1280
    ds_read2_b32 v[72:73], v6 offset0:80 offset1:81
    ds_read2_b32 v[74:75], v6 offset0:82 offset1:83
    s_waitcnt lgkmcnt(14)
    v_mfma_f32_16x16x32_bf16 v[36:39], v[92:95], v[132:135], v[36:39]
    ds_read_b128 v[152:155], v3 offset:1344
    ds_read2_b32 v[68:69], v6 offset0:96 offset1:97
    ds_read2_b32 v[70:71], v6 offset0:98 offset1:99
    v_mfma_f32_16x16x32_bf16 v[40:43], v[124:127], v[132:135], v[40:43]
    v_mfma_f32_16x16x32_bf16 v[48:51], v[160:163], v[132:135], 0
    s_waitcnt lgkmcnt(14)
    v_mfma_f32_16x16x32_bf16 v[36:39], v[88:91], v[136:139], v[36:39]
    ds_read_b128 v[156:159], v3 offset:1408
    ds_read2_b32 v[64:65], v6 offset0:112 offset1:113
    ds_read2_b32 v[66:67], v6 offset0:114 offset1:115
    v_mfma_f32_16x16x32_bf16 v[40:43], v[120:123], v[136:139], v[40:43]
    s_waitcnt lgkmcnt(14)
    v_mfma_f32_16x16x32_bf16 v[36:39], v[84:87], v[140:143], v[36:39]
    ds_read_b128 v[128:131], v3 offset:1472
    ds_read2_b32 v[60:61], v6 offset0:128 offset1:129
    ds_read2_b32 v[62:63], v6 offset0:130 offset1:131
    v_mfma_f32_16x16x32_bf16 v[40:43], v[116:119], v[140:143], v[40:43]
    s_waitcnt lgkmcnt(14)
    v_mfma_f32_16x16x32_bf16 v[36:39], v[80:83], v[144:147], v[36:39]
    ds_read_b128 v[132:135], v3 offset:1536
    v_mfma_f32_16x16x32_bf16 v[40:43], v[112:115], v[144:147], v[40:43]
    s_waitcnt lgkmcnt(12)
    v_mfma_f32_16x16x32_bf16 v[36:39], v[76:79], v[148:151], v[36:39]
    ds_read_b128 v[136:139], v3 offset:1600
    v_mfma_f32_16x16x32_bf16 v[40:43], v[108:111], v[148:151], v[40:43]
    s_waitcnt lgkmcnt(10)
    v_mfma_f32_16x16x32_bf16 v[36:39], v[72:75], v[152:155], v[36:39]
    ds_read_b128 v[140:143], v3 offset:1664
    v_mfma_f32_16x16x32_bf16 v[40:43], v[104:107], v[152:155], v[40:43]
    s_waitcnt lgkmcnt(8)
    v_mfma_f32_16x16x32_bf16 v[36:39], v[68:71], v[156:159], v[36:39]
    ds_read_b128 v[144:147], v3 offset:1728
    v_mfma_f32_16x16x32_bf16 v[40:43], v[100:103], v[156:159], v[40:43]
    s_waitcnt lgkmcnt(6)
    v_mfma_f32_16x16x32_bf16 v[36:39], v[64:67], v[128:131], v[36:39]
    ds_read_b128 v[148:151], v3 offset:1792
    v_mfma_f32_16x16x32_bf16 v[40:43], v[96:99], v[128:131], v[40:43]
    s_waitcnt lgkmcnt(4)
    v_mfma_f32_16x16x32_bf16 v[36:39], v[60:63], v[132:135], v[36:39]
    ds_read_b128 v[152:155], v3 offset:1856
    v_mfma_f32_16x16x32_bf16 v[40:43], v[92:95], v[132:135], v[40:43]
    v_mfma_f32_16x16x32_bf16 v[44:47], v[124:127], v[132:135], v[44:47]
    v_mfma_f32_16x16x32_bf16 v[52:55], v[160:163], v[132:135], 0
    s_waitcnt lgkmcnt(4)
    v_mfma_f32_16x16x32_bf16 v[40:43], v[88:91], v[136:139], v[40:43]
    ds_read_b128 v[156:159], v3 offset:1920
    v_mfma_f32_16x16x32_bf16 v[44:47], v[120:123], v[136:139], v[44:47]
    s_waitcnt lgkmcnt(4)
    v_mfma_f32_16x16x32_bf16 v[40:43], v[84:87], v[140:143], v[40:43]
    ds_read_b128 v[128:131], v3 offset:1984
    v_mfma_f32_16x16x32_bf16 v[44:47], v[116:119], v[140:143], v[44:47]
    s_waitcnt lgkmcnt(4)
    v_mfma_f32_16x16x32_bf16 v[40:43], v[80:83], v[144:147], v[40:43]
    ds_read_b128 v[132:135], v3 offset:2048
    v_mfma_f32_16x16x32_bf16 v[44:47], v[112:115], v[144:147], v[44:47]
    s_waitcnt lgkmcnt(4)
    v_mfma_f32_16x16x32_bf16 v[40:43], v[76:79], v[148:151], v[40:43]
    ds_read_b128 v[136:139], v3 offset:2112
    v_mfma_f32_16x16x32_bf16 v[44:47], v[108:111], v[148:151], v[44:47]
    s_waitcnt lgkmcnt(4)
    v_mfma_f32_16x16x32_bf16 v[40:43], v[72:75], v[152:155], v[40:43]
    ds_read_b128 v[140:143], v3 offset:2176
    v_mfma_f32_16x16x32_bf16 v[44:47], v[104:107], v[152:155], v[44:47]
    s_waitcnt lgkmcnt(4)
    v_mfma_f32_16x16x32_bf16 v[40:43], v[68:71], v[156:159], v[40:43]
    ds_read_b128 v[144:147], v3 offset:2240
    v_mfma_f32_16x16x32_bf16 v[44:47], v[100:103], v[156:159], v[44:47]
    s_waitcnt lgkmcnt(4)
    v_mfma_f32_16x16x32_bf16 v[40:43], v[64:67], v[128:131], v[40:43]
    ds_read_b128 v[148:151], v3 offset:2304
    v_mfma_f32_16x16x32_bf16 v[44:47], v[96:99], v[128:131], v[44:47]
    s_waitcnt lgkmcnt(4)
    v_mfma_f32_16x16x32_bf16 v[40:43], v[60:63], v[132:135], v[40:43]
    ds_read_b128 v[152:155], v3 offset:2368
    v_mfma_f32_16x16x32_bf16 v[44:47], v[92:95], v[132:135], v[44:47]
    v_mfma_f32_16x16x32_bf16 v[48:51], v[124:127], v[132:135], v[48:51]
    v_mfma_f32_16x16x32_bf16 v[56:59], v[160:163], v[132:135], 0
    s_waitcnt lgkmcnt(4)
    v_mfma_f32_16x16x32_bf16 v[44:47], v[88:91], v[136:139], v[44:47]
    ds_read_b128 v[156:159], v3 offset:2432
    v_mfma_f32_16x16x32_bf16 v[48:51], v[120:123], v[136:139], v[48:51]
    s_waitcnt lgkmcnt(4)
    v_mfma_f32_16x16x32_bf16 v[44:47], v[84:87], v[140:143], v[44:47]
    ds_read_b128 v[128:131], v3 offset:2496
    v_mfma_f32_16x16x32_bf16 v[48:51], v[116:119], v[140:143], v[48:51]
    s_waitcnt lgkmcnt(4)
    v_mfma_f32_16x16x32_bf16 v[44:47], v[80:83], v[144:147], v[44:47]
    ds_read_b128 v[132:135], v3 offset:2560
    v_mfma_f32_16x16x32_bf16 v[48:51], v[112:115], v[144:147], v[48:51]
    s_waitcnt lgkmcnt(4)
    v_mfma_f32_16x16x32_bf16 v[44:47], v[76:79], v[148:151], v[44:47]
    ds_read_b128 v[136:139], v3 offset:2624
    v_mfma_f32_16x16x32_bf16 v[48:51], v[108:111], v[148:151], v[48:51]
    s_waitcnt lgkmcnt(4)
    v_mfma_f32_16x16x32_bf16 v[44:47], v[72:75], v[152:155], v[44:47]
    ds_read_b128 v[140:143], v3 offset:2688
    v_mfma_f32_16x16x32_bf16 v[48:51], v[104:107], v[152:155], v[48:51]
    s_waitcnt lgkmcnt(4)
    v_mfma_f32_16x16x32_bf16 v[44:47], v[68:71], v[156:159], v[44:47]
    ds_read_b128 v[144:147], v3 offset:2752
    v_mfma_f32_16x16x32_bf16 v[48:51], v[100:103], v[156:159], v[48:51]
    s_waitcnt lgkmcnt(4)
    v_mfma_f32_16x16x32_bf16 v[44:47], v[64:67], v[128:131], v[44:47]
    ds_read_b128 v[148:151], v3 offset:2816
    v_mfma_f32_16x16x32_bf16 v[48:51], v[96:99], v[128:131], v[48:51]
    s_waitcnt lgkmcnt(4)
    v_mfma_f32_16x16x32_bf16 v[44:47], v[60:63], v[132:135], v[44:47]
    ds_read_b128 v[152:155], v3 offset:2880
    v_mfma_f32_16x16x32_bf16 v[48:51], v[92:95], v[132:135], v[48:51]
    v_mfma_f32_16x16x32_bf16 v[52:55], v[124:127], v[132:135], v[52:55]
    s_waitcnt lgkmcnt(4)
    v_mfma_f32_16x16x32_bf16 v[48:51], v[88:91], v[136:139], v[48:51]
    ds_read_b128 v[156:159], v3 offset:2944
    v_mfma_f32_16x16x32_bf16 v[52:55], v[120:123], v[136:139], v[52:55]
    s_waitcnt lgkmcnt(4)
    v_mfma_f32_16x16x32_bf16 v[48:51], v[84:87], v[140:143], v[48:51]
    ds_read_b128 v[128:131], v3 offset:3008
    v_mfma_f32_16x16x32_bf16 v[52:55], v[116:119], v[140:143], v[52:55]
    s_waitcnt lgkmcnt(4)
    v_mfma_f32_16x16x32_bf16 v[48:51], v[80:83], v[144:147], v[48:51]
    ds_read_b128 v[132:135], v3 offset:3072
    v_mfma_f32_16x16x32_bf16 v[52:55], v[112:115], v[144:147], v[52:55]
    s_waitcnt lgkmcnt(4)
    v_mfma_f32_16x16x32_bf16 v[48:51], v[76:79], v[148:151], v[48:51]
    ds_read_b128 v[136:139], v3 offset:3136
    v_mfma_f32_16x16x32_bf16 v[52:55], v[108:111], v[148:151], v[52:55]
    s_waitcnt lgkmcnt(4)
    v_mfma_f32_16x16x32_bf16 v[48:51], v[72:75], v[152:155], v[48:51]
    ds_read_b128 v[140:143], v3 offset:3200
    v_mfma_f32_16x16x32_bf16 v[52:55], v[104:107], v[152:155], v[52:55]
    s_waitcnt lgkmcnt(4)
    v_mfma_f32_16x16x32_bf16 v[48:51], v[68:71], v[156:159], v[48:51]
    ds_read_b128 v[144:147], v3 offset:3264
    v_mfma_f32_16x16x32_bf16 v[52:55], v[100:103], v[156:159], v[52:55]
    s_waitcnt lgkmcnt(4)
    v_mfma_f32_16x16x32_bf16 v[48:51], v[64:67], v[128:131], v[48:51]
    ds_read_b128 v[148:151], v3 offset:3328
    v_mfma_f32_16x16x32_bf16 v[52:55], v[96:99], v[128:131], v[52:55]
    s_waitcnt lgkmcnt(4)
    v_mfma_f32_16x16x32_bf16 v[48:51], v[60:63], v[132:135], v[48:51]
    ds_read_b128 v[152:155], v3 offset:3392
    v_mfma_f32_16x16x32_bf16 v[52:55], v[92:95], v[132:135], v[52:55]
    v_mfma_f32_16x16x32_bf16 v[56:59], v[124:127], v[132:135], v[56:59]
    s_waitcnt lgkmcnt(4)
    v_mfma_f32_16x16x32_bf16 v[52:55], v[88:91], v[136:139], v[52:55]
    ds_read_b128 v[156:159], v3 offset:3456
    v_mfma_f32_16x16x32_bf16 v[56:59], v[120:123], v[136:139], v[56:59]
    s_waitcnt lgkmcnt(4)
    v_mfma_f32_16x16x32_bf16 v[52:55], v[84:87], v[140:143], v[52:55]
    ds_read_b128 v[128:131], v3 offset:3520
    v_mfma_f32_16x16x32_bf16 v[56:59], v[116:119], v[140:143], v[56:59]
    s_waitcnt lgkmcnt(4)
    v_mfma_f32_16x16x32_bf16 v[52:55], v[80:83], v[144:147], v[52:55]
    ds_read_b128 v[132:135], v3 offset:3584
    v_mfma_f32_16x16x32_bf16 v[56:59], v[112:115], v[144:147], v[56:59]
    s_waitcnt lgkmcnt(4)
    v_mfma_f32_16x16x32_bf16 v[52:55], v[76:79], v[148:151], v[52:55]
    ds_read_b128 v[136:139], v3 offset:3648
    v_mfma_f32_16x16x32_bf16 v[56:59], v[108:111], v[148:151], v[56:59]
    s_waitcnt lgkmcnt(4)
    v_mfma_f32_16x16x32_bf16 v[52:55], v[72:75], v[152:155], v[52:55]
    ds_read_b128 v[140:143], v3 offset:3712
    v_mfma_f32_16x16x32_bf16 v[56:59], v[104:107], v[152:155], v[56:59]
    s_waitcnt lgkmcnt(4)
    v_mfma_f32_16x16x32_bf16 v[52:55], v[68:71], v[156:159], v[52:55]
    ds_read_b128 v[144:147], v3 offset:3776
    v_mfma_f32_16x16x32_bf16 v[56:59], v[100:103], v[156:159], v[56:59]
    s_waitcnt lgkmcnt(4)
    v_mfma_f32_16x16x32_bf16 v[52:55], v[64:67], v[128:131], v[52:55]
    ds_read_b128 v[148:151], v3 offset:3840
    v_mfma_f32_16x16x32_bf16 v[56:59], v[96:99], v[128:131], v[56:59]
    s_waitcnt lgkmcnt(4)
    v_mfma_f32_16x16x32_bf16 v[52:55], v[60:63], v[132:135], v[52:55]
    ds_read_b128 v[152:155], v3 offset:3904
    v_mfma_f32_16x16x32_bf16 v[56:59], v[92:95], v[132:135], v[56:59]
    s_waitcnt lgkmcnt(4)
    v_mfma_f32_16x16x32_bf16 v[56:59], v[88:91], v[136:139], v[56:59]
    ds_read_b128 v[156:159], v3 offset:3968
    s_waitcnt lgkmcnt(4)
    v_mfma_f32_16x16x32_bf16 v[56:59], v[84:87], v[140:143], v[56:59]
    ds_read_b128 v[128:131], v3 offset:4032
    s_waitcnt lgkmcnt(4)
    v_mfma_f32_16x16x32_bf16 v[56:59], v[80:83], v[144:147], v[56:59]
    ds_read_b128 v[132:135], v3 offset:4096
    s_waitcnt lgkmcnt(4)
    v_mfma_f32_16x16x32_bf16 v[56:59], v[76:79], v[148:151], v[56:59]
    s_waitcnt lgkmcnt(3)
    v_mfma_f32_16x16x32_bf16 v[56:59], v[72:75], v[152:155], v[56:59]
    s_waitcnt lgkmcnt(2)
    v_mfma_f32_16x16x32_bf16 v[56:59], v[68:71], v[156:159], v[56:59]
    s_waitcnt lgkmcnt(1)
    v_mfma_f32_16x16x32_bf16 v[56:59], v[64:67], v[128:131], v[56:59]
    s_waitcnt lgkmcnt(0)
    v_mfma_f32_16x16x32_bf16 v[56:59], v[60:63], v[132:135], v[56:59]
    ds_write_b128 v252, v[36:39] offset:0
    ds_write_b128 v252, v[40:43] offset:1024
    s_waitcnt lgkmcnt(0)
    s_barrier
    ds_read_b128 v[128:131], v253 offset:0
    ds_read_b128 v[132:135], v253 offset:1024
    ds_read_b128 v[136:139], v253 offset:2048
    ds_read_b128 v[140:143], v253 offset:3072
    s_waitcnt lgkmcnt(3)
    v_add_f32 v44, v44, v128
    v_add_f32 v45, v45, v129
    v_add_f32 v46, v46, v130
    v_add_f32 v47, v47, v131
    s_waitcnt lgkmcnt(2)
    v_add_f32 v48, v48, v132
    v_add_f32 v49, v49, v133
    v_add_f32 v50, v50, v134
    v_add_f32 v51, v51, v135
    v_cvt_pk_bf16_f32 v12, v44, v45
    v_cvt_pk_bf16_f32 v13, v46, v47
    v_cvt_pk_bf16_f32 v14, v48, v49
    v_cvt_pk_bf16_f32 v15, v50, v51
    s_add_u32 s62, s64, 2097152
    v_permlane16_swap_b32 v12, v14
    v_permlane16_swap_b32 v13, v15
    s_waitcnt lgkmcnt(1)
    v_add_f32 v52, v52, v136
    v_add_f32 v53, v53, v137
    v_add_f32 v54, v54, v138
    v_add_f32 v55, v55, v139
    s_waitcnt lgkmcnt(0)
    v_add_f32 v56, v56, v140
    v_add_f32 v57, v57, v141
    v_add_f32 v58, v58, v142
    v_add_f32 v59, v59, v143
    v_cvt_pk_bf16_f32 v16, v52, v53
    v_cvt_pk_bf16_f32 v17, v54, v55
    v_cvt_pk_bf16_f32 v18, v56, v57
    v_cvt_pk_bf16_f32 v19, v58, v59
    s_add_u32 s63, s64, 3145728
    v_permlane16_swap_b32 v16, v18
    v_permlane16_swap_b32 v17, v19
    s_cmp_eq_u32 s70, 0
    s_cbranch_scc0 A_SM2a
    buffer_store_dwordx4 v[12:15], v26, s[36:39], s62 offen
    buffer_store_dwordx4 v[16:19], v26, s[36:39], s63 offen
    s_branch A_SM2b
A_SM2a:
    buffer_store_dwordx4 v[12:15], v26, s[36:39], s62 offen sc1
    buffer_store_dwordx4 v[16:19], v26, s[36:39], s63 offen sc1
A_SM2b:
    s_branch A_CONV_END
A_CONV_P:
    ds_read_b128 v[128:131], v3 offset:0
    ds_read2_b32 v[124:125], v7 offset0:0 offset1:1
    ds_read2_b32 v[126:127], v7 offset0:2 offset1:3
    ds_read2_b32 v[92:93], v6 offset0:0 offset1:1
    ds_read2_b32 v[94:95], v6 offset0:2 offset1:3
    ds_read_b128 v[132:135], v3 offset:64
    ds_read2_b32 v[120:121], v7 offset0:16 offset1:17
    ds_read2_b32 v[122:123], v7 offset0:18 offset1:19
    ds_read2_b32 v[88:89], v6 offset0:16 offset1:17
    ds_read2_b32 v[90:91], v6 offset0:18 offset1:19
    ds_read_b128 v[136:139], v3 offset:128
    ds_read2_b32 v[116:117], v7 offset0:32 offset1:33
    ds_read2_b32 v[118:119], v7 offset0:34 offset1:35
    ds_read2_b32 v[84:85], v6 offset0:32 offset1:33
    ds_read2_b32 v[86:87], v6 offset0:34 offset1:35
    s_waitcnt lgkmcnt(12)
    v_mfma_f32_16x16x32_bf16 v[32:35], v[124:127], v[128:131], 0
    ds_read_b128 v[140:143], v3 offset:192
    ds_read2_b32 v[112:113], v7 offset0:48 offset1:49
    ds_read2_b32 v[114:115], v7 offset0:50 offset1:51
    ds_read2_b32 v[80:81], v6 offset0:48 offset1:49
    ds_read2_b32 v[82:83], v6 offset0:50 offset1:51
    s_waitcnt lgkmcnt(14)
    v_mfma_f32_16x16x32_bf16 v[28:31], v[92:95], v[128:131], 0
    s_waitcnt lgkmcnt(12)
    v_mfma_f32_16x16x32_bf16 v[32:35], v[120:123], v[132:135], v[32:35]
    ds_read_b128 v[144:147], v3 offset:256
    ds_read2_b32 v[108:109], v7 offset0:64 offset1:65
    ds_read2_b32 v[110:111], v7 offset0:66 offset1:67
    ds_read2_b32 v[76:77], v6 offset0:64 offset1:65
    ds_read2_b32 v[78:79], v6 offset0:66 offset1:67
    s_waitcnt lgkmcnt(14)
    v_mfma_f32_16x16x32_bf16 v[28:31], v[88:91], v[132:135], v[28:31]
    s_waitcnt lgkmcnt(12)
    v_mfma_f32_16x16x32_bf16 v[32:35], v[116:119], v[136:139], v[32:35]
    ds_read_b128 v[148:151], v3 offset:320
    ds_read2_b32 v[104:105], v7 offset0:80 offset1:81
    ds_read2_b32 v[106:107], v7 offset0:82 offset1:83
    ds_read2_b32 v[72:73], v6 offset0:80 offset1:81
    ds_read2_b32 v[74:75], v6 offset0:82 offset1:83
    s_waitcnt lgkmcnt(14)
    v_mfma_f32_16x16x32_bf16 v[28:31], v[84:87], v[136:139], v[28:31]
    s_waitcnt lgkmcnt(12)
    v_mfma_f32_16x16x32_bf16 v[32:35], v[112:115], v[140:143], v[32:35]
    ds_read_b128 v[152:155], v3 offset:384
    ds_read2_b32 v[100:101], v7 offset0:96 offset1:97
    ds_read2_b32 v[102:103], v7 offset0:98 offset1:99
    ds_read2_b32 v[68:69], v6 offset0:96 offset1:97
    ds_read2_b32 v[70:71], v6 offset0:98 offset1:99
    s_waitcnt lgkmcnt(14)
    v_mfma_f32_16x16x32_bf16 v[28:31], v[80:83], v[140:143], v[28:31]
    s_waitcnt lgkmcnt(12)
    v_mfma_f32_16x16x32_bf16 v[32:35], v[108:111], v[144:147], v[32:35]
    ds_read_b128 v[156:159], v3 offset:448
    ds_read2_b32 v[96:97], v7 offset0:112 offset1:113
    ds_read2_b32 v[98:99], v7 offset0:114 offset1:115
    ds_read2_b32 v[64:65], v6 offset0:112 offset1:113
    ds_read2_b32 v[66:67], v6 offset0:114 offset1:115
    s_waitcnt lgkmcnt(14)
    v_mfma_f32_16x16x32_bf16 v[28:31], v[76:79], v[144:147], v[28:31]
    s_waitcnt lgkmcnt(12)
    v_mfma_f32_16x16x32_bf16 v[32:35], v[104:107], v[148:151], v[32:35]
    ds_read_b128 v[128:131], v3 offset:512
    ds_read2_b32 v[60:61], v6 offset0:128 offset1:129
    ds_read2_b32 v[62:63], v6 offset0:130 offset1:131
    ds_read_b64 v[160:161], v8 offset:24
    ds_read_b64 v[162:163], v8 offset:16
    ds_read_b64 v[164:165], v8 offset:8
    s_waitcnt lgkmcnt(14)
    v_mfma_f32_16x16x32_bf16 v[28:31], v[72:75], v[148:151], v[28:31]
    s_waitcnt lgkmcnt(13)
    v_mfma_f32_16x16x32_bf16 v[32:35], v[100:103], v[152:155], v[32:35]
    ds_read_b128 v[132:135], v3 offset:576
    ds_read_b64 v[166:167], v8 offset:0
    ds_read_b64 v[168:169], v8 offset:152
    ds_read_b64 v[170:171], v8 offset:144
    s_waitcnt lgkmcnt(14)
    v_mfma_f32_16x16x32_bf16 v[28:31], v[68:71], v[152:155], v[28:31]
    s_waitcnt lgkmcnt(12)
    v_mfma_f32_16x16x32_bf16 v[32:35], v[96:99], v[156:159], v[32:35]
    ds_read_b128 v[136:139], v3 offset:640
    ds_read_b64 v[172:173], v8 offset:136
    ds_read_b64 v[174:175], v8 offset:128
    ds_read_b64 v[176:177], v8 offset:280
    s_waitcnt lgkmcnt(14)
    v_mfma_f32_16x16x32_bf16 v[28:31], v[64:67], v[156:159], v[28:31]
    s_waitcnt lgkmcnt(13)
    v_mfma_f32_16x16x32_bf16 v[32:35], v[92:95], v[128:131], v[32:35]
    ds_read_b128 v[140:143], v3 offset:704
    ds_read_b64 v[178:179], v8 offset:272
    ds_read_b64 v[180:181], v8 offset:264
    ds_read_b64 v[182:183], v8 offset:256
    s_waitcnt lgkmcnt(14)
    v_mfma_f32_16x16x32_bf16 v[28:31], v[60:63], v[128:131], v[28:31]
    s_waitcnt lgkmcnt(11)
    v_mfma_f32_16x16x32_bf16 v[32:35], v[88:91], v[132:135], v[32:35]
    ds_read_b128 v[144:147], v3 offset:768
    ds_read2_b32 v[184:185], v9 offset0:3 offset1:2
    ds_read2_b32 v[186:187], v9 offset0:1 offset1:0
    ds_read2_b32 v[188:189], v9 offset0:19 offset1:18
    s_waitcnt lgkmcnt(11)
    v_mfma_f32_16x16x32_bf16 v[32:35], v[84:87], v[136:139], v[32:35]
    ds_read_b128 v[148:151], v3 offset:832
    ds_read2_b32 v[190:191], v9 offset0:17 offset1:16
    ds_read2_b32 v[192:193], v9 offset0:35 offset1:34
    ds_read2_b32 v[194:195], v9 offset0:33 offset1:32
    s_waitcnt lgkmcnt(11)
    v_mfma_f32_16x16x32_bf16 v[32:35], v[80:83], v[140:143], v[32:35]
    ds_read_b128 v[152:155], v3 offset:896
    ds_read2_b32 v[196:197], v9 offset0:51 offset1:50
    ds_read2_b32 v[198:199], v9 offset0:49 offset1:48
    s_waitcnt lgkmcnt(10)
    v_mfma_f32_16x16x32_bf16 v[32:35], v[76:79], v[144:147], v[32:35]
    ds_read_b128 v[156:159], v3 offset:960
    s_waitcnt lgkmcnt(7)
    v_mfma_f32_16x16x32_bf16 v[32:35], v[72:75], v[148:151], v[32:35]
    ds_read_b128 v[128:131], v3 offset:1024
    s_waitcnt lgkmcnt(4)
    v_mfma_f32_16x16x32_bf16 v[32:35], v[68:71], v[152:155], v[32:35]
    s_waitcnt lgkmcnt(1)
    v_mfma_f32_16x16x32_bf16 v[32:35], v[64:67], v[156:159], v[32:35]
    s_waitcnt lgkmcnt(0)
    v_mfma_f32_16x16x32_bf16 v[32:35], v[60:63], v[128:131], v[32:35]
    ds_read_b128 v[128:131], v3 offset:496
    ds_read_b128 v[132:135], v3 offset:480
    ds_read_b128 v[136:139], v3 offset:1008
    ds_read_b128 v[140:143], v3 offset:992
    s_waitcnt lgkmcnt(3)
    v_mfma_f32_16x16x32_bf16 v[200:203], v[128:131], v[224:227], 0
    v_mfma_f32_16x16x32_bf16 v[204:207], v[128:131], v[228:231], 0
    v_mfma_f32_16x16x32_bf16 v[208:211], v[128:131], v[232:235], 0
    s_waitcnt lgkmcnt(2)
    v_mfma_f32_16x16x32_bf16 v[212:215], v[132:135], v[228:231], 0
    v_mfma_f32_16x16x32_bf16 v[216:219], v[128:131], v[240:243], 0
    v_mfma_f32_16x16x32_bf16 v[220:223], v[132:135], v[244:247], 0
    ds_read_b128 v[144:147], v3 offset:1520
    ds_read_b128 v[148:151], v3 offset:1504
    s_nop 0
    v_cvt_pk_bf16_f32 v60, v200, v204
    s_nop 1
    v_cvt_pk_bf16_f32 v61, v208, v212
    v_cvt_pk_bf16_f32 v62, v201, v205
    v_cvt_pk_bf16_f32 v63, v209, v213
    v_cvt_pk_bf16_f32 v64, v202, v206
    v_cvt_pk_bf16_f32 v65, v210, v214
    v_cvt_pk_bf16_f32 v66, v203, v207
    v_cvt_pk_bf16_f32 v67, v211, v215
    v_cvt_pk_bf16_f32 v68, v216, v220
    v_cvt_pk_bf16_f32 v69, v217, v221
    v_cvt_pk_bf16_f32 v70, v218, v222
    v_cvt_pk_bf16_f32 v71, v219, v223
    s_waitcnt lgkmcnt(3)
    v_mfma_f32_16x16x32_bf16 v[200:203], v[136:139], v[224:227], 0
    v_mfma_f32_16x16x32_bf16 v[204:207], v[136:139], v[228:231], 0
    v_mfma_f32_16x16x32_bf16 v[208:211], v[136:139], v[232:235], 0
    s_waitcnt lgkmcnt(2)
    v_mfma_f32_16x16x32_bf16 v[212:215], v[140:143], v[228:231], 0
    v_mfma_f32_16x16x32_bf16 v[216:219], v[136:139], v[240:243], 0
    v_mfma_f32_16x16x32_bf16 v[220:223], v[140:143], v[244:247], 0
    ds_read_b128 v[128:131], v3 offset:2032
    ds_read_b128 v[132:135], v3 offset:2016
    v_mfma_f32_16x16x32_bf16 v[36:39], v[60:63], v[160:163], 0
    v_mfma_f32_16x16x32_bf16 v[36:39], v[64:67], v[164:167], v[36:39]
    v_mfma_f32_16x16x32_bf16 v[40:43], v[60:63], v[168:171], 0
    v_cvt_pk_bf16_f32 v12, v28, v29
    v_cvt_pk_bf16_f32 v13, v30, v31
    v_cvt_pk_bf16_f32 v14, v32, v33
    v_cvt_pk_bf16_f32 v15, v34, v35
    s_add_u32 s62, s64, 0
    v_permlane16_swap_b32 v12, v14
    v_permlane16_swap_b32 v13, v15
    v_mfma_f32_16x16x32_bf16 v[40:43], v[64:67], v[172:175], v[40:43]
    v_cvt_pk_bf16_f32 v72, v200, v204
    v_mfma_f32_16x16x32_bf16 v[44:47], v[60:63], v[176:179], 0
    v_cvt_pk_bf16_f32 v73, v208, v212
    v_cvt_pk_bf16_f32 v74, v201, v205
    v_mfma_f32_16x16x32_bf16 v[44:47], v[64:67], v[180:183], v[44:47]
    v_cvt_pk_bf16_f32 v75, v209, v213
    v_cvt_pk_bf16_f32 v76, v202, v206
    v_mfma_f32_16x16x32_bf16 v[44:47], v[68:71], v[184:187], v[44:47]
    v_cvt_pk_bf16_f32 v77, v210, v214
    v_mfma_f32_16x16x32_bf16 v[48:51], v[68:71], v[188:191], 0
    v_cvt_pk_bf16_f32 v78, v203, v207
    v_cvt_pk_bf16_f32 v79, v211, v215
    v_mfma_f32_16x16x32_bf16 v[52:55], v[68:71], v[192:195], 0
    v_cvt_pk_bf16_f32 v80, v216, v220
    v_cvt_pk_bf16_f32 v81, v217, v221
    v_mfma_f32_16x16x32_bf16 v[56:59], v[68:71], v[196:199], 0
    v_cvt_pk_bf16_f32 v82, v218, v222
    v_cvt_pk_bf16_f32 v83, v219, v223
    s_waitcnt lgkmcnt(3)
    v_mfma_f32_16x16x32_bf16 v[200:203], v[144:147], v[224:227], 0
    v_mfma_f32_16x16x32_bf16 v[204:207], v[144:147], v[228:231], 0
    v_mfma_f32_16x16x32_bf16 v[208:211], v[144:147], v[232:235], 0
    s_waitcnt lgkmcnt(2)
    v_mfma_f32_16x16x32_bf16 v[212:215], v[148:151], v[228:231], 0
    v_mfma_f32_16x16x32_bf16 v[216:219], v[144:147], v[240:243], 0
    v_mfma_f32_16x16x32_bf16 v[220:223], v[148:151], v[244:247], 0
    ds_read_b128 v[136:139], v3 offset:2544
    ds_read_b128 v[140:143], v3 offset:2528
    v_mfma_f32_16x16x32_bf16 v[40:43], v[72:75], v[160:163], v[40:43]
    v_mfma_f32_16x16x32_bf16 v[40:43], v[76:79], v[164:167], v[40:43]
    v_mfma_f32_16x16x32_bf16 v[44:47], v[72:75], v[168:171], v[44:47]
    v_mfma_f32_16x16x32_bf16 v[44:47], v[76:79], v[172:175], v[44:47]
    v_cvt_pk_bf16_f32 v60, v200, v204
    v_cvt_pk_bf16_f32 v61, v208, v212
    v_mfma_f32_16x16x32_bf16 v[48:51], v[72:75], v[176:179], v[48:51]
    v_cvt_pk_bf16_f32 v62, v201, v205
    v_cvt_pk_bf16_f32 v63, v209, v213
    v_mfma_f32_16x16x32_bf16 v[48:51], v[76:79], v[180:183], v[48:51]
    v_cvt_pk_bf16_f32 v64, v202, v206
    v_cvt_pk_bf16_f32 v65, v210, v214
    v_mfma_f32_16x16x32_bf16 v[48:51], v[80:83], v[184:187], v[48:51]
    v_cvt_pk_bf16_f32 v66, v203, v207
    v_cvt_pk_bf16_f32 v67, v211, v215
    v_mfma_f32_16x16x32_bf16 v[52:55], v[80:83], v[188:191], v[52:55]
    v_cvt_pk_bf16_f32 v68, v216, v220
    v_cvt_pk_bf16_f32 v69, v217, v221
    v_mfma_f32_16x16x32_bf16 v[56:59], v[80:83], v[192:195], v[56:59]
    v_cvt_pk_bf16_f32 v70, v218, v222
    v_cvt_pk_bf16_f32 v71, v219, v223
    s_waitcnt lgkmcnt(3)
    v_mfma_f32_16x16x32_bf16 v[200:203], v[128:131], v[224:227], 0
    v_mfma_f32_16x16x32_bf16 v[204:207], v[128:131], v[228:231], 0
    v_mfma_f32_16x16x32_bf16 v[208:211], v[128:131], v[232:235], 0
    s_waitcnt lgkmcnt(2)
    v_mfma_f32_16x16x32_bf16 v[212:215], v[132:135], v[228:231], 0
    v_mfma_f32_16x16x32_bf16 v[216:219], v[128:131], v[240:243], 0
    v_mfma_f32_16x16x32_bf16 v[220:223], v[132:135], v[244:247], 0
    ds_read_b128 v[144:147], v3 offset:3056
    ds_read_b128 v[148:151], v3 offset:3040
    v_mfma_f32_16x16x32_bf16 v[44:47], v[60:63], v[160:163], v[44:47]
    v_mfma_f32_16x16x32_bf16 v[44:47], v[64:67], v[164:167], v[44:47]
    v_mfma_f32_16x16x32_bf16 v[48:51], v[60:63], v[168:171], v[48:51]
    v_mfma_f32_16x16x32_bf16 v[48:51], v[64:67], v[172:175], v[48:51]
    v_cvt_pk_bf16_f32 v72, v200, v204
    v_cvt_pk_bf16_f32 v73, v208, v212
    v_mfma_f32_16x16x32_bf16 v[52:55], v[60:63], v[176:179], v[52:55]
    v_cvt_pk_bf16_f32 v74, v201, v205
    v_cvt_pk_bf16_f32 v75, v209, v213
    v_mfma_f32_16x16x32_bf16 v[52:55], v[64:67], v[180:183], v[52:55]
    v_cvt_pk_bf16_f32 v76, v202, v206
    v_cvt_pk_bf16_f32 v77, v210, v214
    v_cvt_pk_bf16_f32 v78, v203, v207
    v_mfma_f32_16x16x32_bf16 v[52:55], v[68:71], v[184:187], v[52:55]
    v_cvt_pk_bf16_f32 v79, v211, v215
    v_cvt_pk_bf16_f32 v80, v216, v220
    v_mfma_f32_16x16x32_bf16 v[56:59], v[68:71], v[188:191], v[56:59]
    v_cvt_pk_bf16_f32 v81, v217, v221
    v_cvt_pk_bf16_f32 v82, v218, v222
    v_cvt_pk_bf16_f32 v83, v219, v223
    s_waitcnt lgkmcnt(3)
    v_mfma_f32_16x16x32_bf16 v[200:203], v[136:139], v[224:227], 0
    v_mfma_f32_16x16x32_bf16 v[204:207], v[136:139], v[228:231], 0
    v_mfma_f32_16x16x32_bf16 v[208:211], v[136:139], v[232:235], 0
    s_waitcnt lgkmcnt(2)
    v_mfma_f32_16x16x32_bf16 v[212:215], v[140:143], v[228:231], 0
    v_mfma_f32_16x16x32_bf16 v[48:51], v[72:75], v[160:163], v[48:51]
    v_mfma_f32_16x16x32_bf16 v[48:51], v[76:79], v[164:167], v[48:51]
    v_mfma_f32_16x16x32_bf16 v[52:55], v[72:75], v[168:171], v[52:55]
    v_mfma_f32_16x16x32_bf16 v[52:55], v[76:79], v[172:175], v[52:55]
    s_nop 0
    v_cvt_pk_bf16_f32 v60, v200, v204
    s_nop 1
    v_cvt_pk_bf16_f32 v61, v208, v212
    v_mfma_f32_16x16x32_bf16 v[56:59], v[72:75], v[176:179], v[56:59]
    v_cvt_pk_bf16_f32 v62, v201, v205
    v_cvt_pk_bf16_f32 v63, v209, v213
    v_mfma_f32_16x16x32_bf16 v[56:59], v[76:79], v[180:183], v[56:59]
    v_cvt_pk_bf16_f32 v64, v202, v206
    v_cvt_pk_bf16_f32 v65, v210, v214
    v_mfma_f32_16x16x32_bf16 v[56:59], v[80:83], v[184:187], v[56:59]
    v_cvt_pk_bf16_f32 v66, v203, v207
    v_cvt_pk_bf16_f32 v67, v211, v215
    s_waitcnt lgkmcnt(1)
    v_mfma_f32_16x16x32_bf16 v[200:203], v[144:147], v[224:227], 0
    v_mfma_f32_16x16x32_bf16 v[204:207], v[144:147], v[228:231], 0
    v_mfma_f32_16x16x32_bf16 v[208:211], v[144:147], v[232:235], 0
    s_waitcnt lgkmcnt(0)
    v_mfma_f32_16x16x32_bf16 v[212:215], v[148:151], v[228:231], 0
    v_mfma_f32_16x16x32_bf16 v[52:55], v[60:63], v[160:163], v[52:55]
    v_mfma_f32_16x16x32_bf16 v[52:55], v[64:67], v[164:167], v[52:55]
    v_mfma_f32_16x16x32_bf16 v[56:59], v[60:63], v[168:171], v[56:59]
    v_mfma_f32_16x16x32_bf16 v[56:59], v[64:67], v[172:175], v[56:59]
    s_nop 0
    v_cvt_pk_bf16_f32 v72, v200, v204
    s_nop 1
    v_cvt_pk_bf16_f32 v73, v208, v212
    v_cvt_pk_bf16_f32 v74, v201, v205
    v_cvt_pk_bf16_f32 v75, v209, v213
    v_cvt_pk_bf16_f32 v76, v202, v206
    v_cvt_pk_bf16_f32 v77, v210, v214
    v_cvt_pk_bf16_f32 v78, v203, v207
    v_cvt_pk_bf16_f32 v79, v211, v215
    v_mfma_f32_16x16x32_bf16 v[56:59], v[72:75], v[160:163], v[56:59]
    s_nop 0
    v_mfma_f32_16x16x32_bf16 v[56:59], v[76:79], v[164:167], v[56:59]
    ds_write_b128 v252, v[44:47] offset:0
    ds_write_b128 v252, v[48:51] offset:1024
    ds_write_b128 v252, v[52:55] offset:2048
    s_nop 4
    ds_write_b128 v252, v[56:59] offset:3072
    s_waitcnt lgkmcnt(0)
    s_barrier
    ds_read_b128 v[128:131], v253 offset:0
    ds_read_b128 v[132:135], v253 offset:1024
    s_waitcnt lgkmcnt(1)
    v_add_f32 v36, v36, v128
    v_add_f32 v37, v37, v129
    v_add_f32 v38, v38, v130
    v_add_f32 v39, v39, v131
    s_waitcnt lgkmcnt(0)
    v_add_f32 v40, v40, v132
    v_add_f32 v41, v41, v133
    v_add_f32 v42, v42, v134
    v_add_f32 v43, v43, v135
    v_cvt_pk_bf16_f32 v16, v36, v37
    v_cvt_pk_bf16_f32 v17, v38, v39
    v_cvt_pk_bf16_f32 v18, v40, v41
    v_cvt_pk_bf16_f32 v19, v42, v43
    s_add_u32 s63, s64, 1048576
    v_permlane16_swap_b32 v16, v18
    v_permlane16_swap_b32 v17, v19
    s_cmp_eq_u32 s70, 0
    s_cbranch_scc0 A_SM3a
    buffer_store_dwordx4 v[12:15], v26, s[36:39], s62 offen
    buffer_store_dwordx4 v[16:19], v26, s[36:39], s63 offen
    s_branch A_SM3b
A_SM3a:
    buffer_store_dwordx4 v[12:15], v26, s[36:39], s62 offen sc1
    buffer_store_dwordx4 v[16:19], v26, s[36:39], s63 offen sc1
A_SM3b:
A_CONV_END:
    v_mov_b32 v28, s58
    v_mov_b32 v29, s58
    v_mov_b32 v30, s58
    v_mov_b32 v31, s58
    s_lshl_b32 s49, s44, 5
    s_add_u32 s49, s49, s45
    s_lshl2_add_u32 s49, s49, s46
    s_lshl_b32 s49, s49, 4
    s_add_u32 s49, s49, 393216
    v_and_b32 v3, 7, v0
    v_bfe_u32 v4, v0, 3, 1
    v_lshl_add_u32 v3, v4, 5, v3
    v_lshlrev_b32 v3, 5, v3
    s_cmp_lt_u32 s45, 16
    s_cselect_b32 s50, 16, 0
    s_lshl_b32 s51, s44, 3
    s_add_u32 s51, s51, s46
    s_lshl_b32 s51, s51, 8
    s_add_u32 s50, s50, s51
    s_add_u32 s62, s50, 393216
    v_bfe_u32 v4, v0, 4, 1
    v_lshlrev_b32 v4, 2, v4
    v_and_b32 v5, 7, v0
    v_xor_b32 v4, v4, v5
    v_lshlrev_b32 v4, 4, v4
    v_lshrrev_b32 v5, 3, v0
    v_lshl_add_u32 v4, v5, 11, v4
    s_lshl_b32 s50, s46, 10
    s_add_u32 m0, s50, 16384
    s_waitcnt vmcnt(0)
    s_mov_b64 exec, 1
    s_cmp_eq_u32 s70, 0
    s_cbranch_scc0 A_SM4a
    buffer_store_dwordx4 v[28:31], v27, s[40:43], s49 offen
    s_branch A_SM4b
A_SM4a:
    buffer_store_dwordx4 v[28:31], v27, s[40:43], s49 offen sc1
A_SM4b:
    s_mov_b64 exec, -1
    v_subrev_u32 v21, 45632, v21
    v_bfe_u32 v6, v0, 3, 2
    v_lshlrev_b32 v6, 4, v6
    v_bfe_u32 v7, v0, 5, 1
    v_lshl_add_u32 v6, v7, 3, v6
    v_and_b32 v7, 7, v0
    v_add_u32 v6, v6, v7
    s_lshl_b32 s49, s46, 1
    v_xor_b32 v7, s49, v7
    v_lshlrev_b32 v7, 4, v7
    v_lshl_add_u32 v6, v6, 7, v7
    v_add_u32 v6, 24576, v6
    v_xor_b32 v7, 16, v6
    v_lshlrev_b32 v9, 4, v0
    s_mov_b32 s68, 0
A_Y_POLL:
    buffer_load_dword v18, v3, s[40:43], s62 offen sc1
    s_add_u32 s68, s68, 1
    s_cmp_gt_u32 s68, 200000
    s_cbranch_scc1 A_Y_LOAD
    s_waitcnt vmcnt(0)
    v_cmp_ne_u32 vcc, s58, v18
    s_nop 0
    s_cbranch_vccz A_Y_LOAD
    s_sleep 4
    s_branch A_Y_POLL
A_Y_LOAD:
    buffer_load_dwordx4 v4, s[36:39], s71 offen sc1 lds
    s_add_u32 m0, s50, 20480
    s_nop 0
    buffer_load_dwordx4 v4, s[36:39], s72 offen sc1 lds
    s_waitcnt vmcnt(0)
    s_barrier
    ds_read_b64_tr_b16 v[96:97], v21 offset:0
    ds_read_b64_tr_b16 v[98:99], v21 offset:512
    ds_read_b64_tr_b16 v[100:101], v21 offset:1024
    ds_read_b64_tr_b16 v[102:103], v21 offset:1536
    s_waitcnt lgkmcnt(2)
    ds_write_b128 v6, v[96:99]
    s_waitcnt lgkmcnt(1)
    ds_write_b128 v7, v[100:103]
    s_waitcnt lgkmcnt(0)
    s_barrier
    ds_read_b128 v[52:55], v9 offset:24576
    ds_read_b128 v[56:59], v9 offset:28672
    s_waitcnt lgkmcnt(0)
    buffer_store_dwordx4 v[52:55], v25, s[36:39], s71 offen nt
    buffer_store_dwordx4 v[56:59], v25, s[36:39], s72 offen nt
    s_or_b32 s49, s45, s46
    s_cmp_lg_u32 s49, 0
    s_cbranch_scc1 A_END
    v_mov_b32 v10, s58
    v_mov_b32 v11, 0
    s_lshl_b32 s49, s44, 8
    s_mov_b64 exec, 1
    buffer_store_dword v10, v11, s[40:43], s49 offen offset:256 sc1
A_END:
    s_endpgm
A_X_AGAIN:
    s_add_u32 s68, s68, 1
    s_cmp_gt_u32 s68, 200000
    s_cbranch_scc1 A_X_OK
    s_sleep 8
    buffer_load_dwordx2 v[110:111], v108, s[40:43], s73 offen sc1
    s_waitcnt vmcnt(0)
    s_branch A_X_CHK
K_EXIT:
    s_endpgm
    .fill (concat_heads__ssm_conv_s4__linear_kernel_hedgehog__prompt_kernel + 33024 - .) / 4, 4, 0xbf810000
.section .rodata,"a"
.p2align 6
.amdhsa_kernel concat_heads__ssm_conv_s4__linear_kernel_hedgehog__prompt_kernel
  .amdhsa_next_free_vgpr 256
  .amdhsa_next_free_sgpr 102
  .amdhsa_accum_offset 256
  .amdhsa_group_segment_fixed_size 0
  .amdhsa_kernarg_size 128
  .amdhsa_user_sgpr_count 2
  .amdhsa_user_sgpr_kernarg_segment_ptr 1
  .amdhsa_system_sgpr_workgroup_id_x 1
.end_amdhsa_kernel
```
